```python
import torch

def _softmax(x, axis=-1):
    return torch.softmax(x, dim=axis)
def _gelu(x):
    return torch.nn.functional.gelu(x, approximate="tanh")
def _silu(x):
    return torch.nn.functional.silu(x)
def _sigmoid(x):
    return torch.sigmoid(x)
def _layernorm(x, axis=-1, eps=1e-5):
    m = x.mean(dim=axis, keepdim=True)
    v = x.var(dim=axis, keepdim=True, unbiased=False)
    return (x - m) / torch.sqrt(v + eps)
def _scatter_add(tgt, idx, src, axis=0):
    return tgt.clone().index_add_(axis, idx, src)
def _segment_sum(src, seg, n):
    out = torch.zeros((n,) + src.shape[1:], dtype=src.dtype)
    return out.index_add_(0, seg, src)
def _pad(x, pw):
    flat = tuple(v for pair in reversed(pw) for v in pair)
    return torch.nn.functional.pad(x, flat)

kernel_name = 'standalone__weight_only_int_quip__prompt'

def setup_inputs():

    _w = (lambda a: (lambda t: t.to(torch.bfloat16) if t.is_floating_point() else t)(torch.as_tensor(a)))
    B, S, D, F = 1, 2048, 1024, 3584
    G = 128 if 128 > 0 else D
    D = (D // G) * G
    ng = D // G
    bits = 3 if 3 > 0 else 4
    qmax = 1 << bits
    qw = torch.randint(0, qmax, (D, F)).to(torch.int32)
    U, _ = (lambda *_a, **_k: torch.linalg.qr(*[torch.as_tensor(_x).float() for _x in _a], **_k))((lambda *s: torch.randn(*s, dtype=torch.bfloat16) * 0.05)(D, D))
    V, _ = (lambda *_a, **_k: torch.linalg.qr(*[torch.as_tensor(_x).float() for _x in _a], **_k))((lambda *s: torch.randn(*s, dtype=torch.bfloat16) * 0.05)(F, F))
    return {
        "x": _w((lambda *s: torch.randn(*s, dtype=torch.bfloat16) * 0.05)(B, S, D)),
        "qw": _w(qw),
        "scales": _w(torch.abs((lambda *s: torch.randn(*s, dtype=torch.bfloat16) * 0.05)(ng, F)) * 0.02 + 0.005),
        "zeros": _w(torch.full((ng, F), qmax / 2.0, dtype=float)),
        "U": _w(U.to(float)),
        "V": _w(V.to(float)),
    }

def reference(x, qw, scales, zeros, U, V):
    B, S, D = x.shape
    ng, F = scales.shape
    G = D // ng
    s = (lambda x, n, axis: torch.repeat_interleave(x, n, dim=axis))(scales, G, axis=0)
    z = (lambda x, n, axis: torch.repeat_interleave(x, n, dim=axis))(zeros, G, axis=0)
    wq = ((lambda x, dt: x.to(dt))(qw, x.dtype) - z) * s
    xr = torch.einsum("bsd,de->bse", x, U)
    h  = torch.einsum("bse,ef->bsf", xr, wq)
    y  = torch.einsum("bsf,fg->bsg", h, V)
    return y
```

```asm
; @launch grid=(256,1,1) block=(512,1,1) lds=163840
.amdgcn_target "amdgcn-amd-amdhsa--gfx950"
.text
.globl standalone__weight_only_int_quip__prompt_kernel
.p2align 8
.type standalone__weight_only_int_quip__prompt_kernel,@function
standalone__weight_only_int_quip__prompt_kernel:
    s_cmp_ge_u32 s2, 256
    s_cbranch_scc1 L_quip_kernel_end
    s_load_dwordx16 s[4:19], s[0:1], 0
    s_load_dwordx2 s[20:21], s[0:1], 64
    s_memrealtime s[22:23]
    v_lshrrev_b32 v1, 6, v0
    v_and_b32 v2, 63, v0
    s_and_b32 s66, s2, 7
    v_readfirstlane_b32 s43, v1
    s_lshr_b32 s67, s2, 3
    v_and_b32 v3, 15, v2
    v_lshrrev_b32 v4, 4, v2
    s_and_b32 s44, s43, 1
    s_lshr_b32 s45, s43, 1
    s_sub_u32 s59, s43, 4
    s_waitcnt lgkmcnt(0)
    s_mov_b32 s32, s20
    s_mov_b32 s33, s21
    s_mov_b32 s34, 268435456
    s_mov_b32 s35, 0x20000
    s_cmp_eq_u32 s2, 0
    s_cbranch_scc0 L_quip_kernel_nn
    s_cmp_eq_u32 s43, 0
    s_cbranch_scc0 L_quip_kernel_nn
    s_or_b32 s22, s22, 1
    v_mov_b32 v24, 0
    v_mov_b32 v25, s22
    s_mov_b64 exec, 1
    global_store_dword v24, v25, s[18:19] sc1
    s_mov_b64 exec, -1
L_quip_kernel_nn:
    s_cmp_lt_u32 s67, 28
    s_cbranch_scc1 L_quip_kernel_A2
    s_getpc_b64 s[22:23]
L_quip_kernel_pc0:
    v_lshlrev_b32 v5, 7, v0
    v_min_u32 v5, L_quip_kernel_end-L_quip_kernel_pc0, v5
    v_and_b32 v5, -4, v5
    s_cmp_lt_u32 s43, 4
    s_cbranch_scc0 L_quip_kernel_A1
    global_load_dword v14, v5, s[22:23]
    s_branch L_quip_kernel_A1
L_quip_kernel_A2:
    s_and_b32 s74, s66, 1
    s_and_b32 s42, s67, 3
    s_lshl_b32 s40, s74, 2
    s_add_u32 s40, s40, s42
    s_lshr_b32 s52, s66, 1
    s_mul_i32 s41, s52, 7
    s_cmp_eq_u32 s52, 3
    s_cselect_b32 s75, 4, 0
    s_lshr_b32 s53, s67, 2
    s_add_u32 s41, s41, s53
    s_add_u32 s42, s42, s53
    s_and_b32 s42, s42, 3
    s_add_u32 s42, s41, 3
    s_lshr_b32 s42, s42, 2
    s_sub_u32 s42, s41, s42
    s_add_u32 s42, s42, s40
    s_and_b32 s42, s42, 3
    s_cmp_ge_u32 s53, 6
    s_cselect_b32 s52, -6, 1
    s_add_u32 s73, s41, s52
    s_cmp_lt_u32 s43, 4
    s_cbranch_scc0 L_quip_kernel_A2l
    s_mov_b32 s36, s6
    s_mov_b32 s37, s7
    s_mov_b32 s38, 14680064
    s_mov_b32 s39, 0x20000
    v_mul_u32_u24 v32, 14336, v4
    v_lshl_add_u32 v32, v3, 4, v32
    s_mul_i32 s68, s74, 28
    s_add_u32 s68, s68, s73
    s_xor_b32 s69, s40, 4
    s_mul_i32 s54, s43, 458752
    s_lshl_b32 s53, s68, 8
    s_add_u32 s54, s54, s53
    s_mul_i32 s52, s40, 1835008
    s_add_u32 s52, s52, s54
    s_mul_i32 s53, s69, 1835008
    s_add_u32 s53, s53, s54
    buffer_load_dwordx4 v[64:67], v32, s[36:39], s52 offen nt
    buffer_load_dwordx4 v[68:71], v32, s[36:39], s53 offen nt
    s_lshl_b32 s54, s68, 7
    v_lshl_add_u32 v33, v3, 3, s54
    s_mul_i32 s54, s69, 7168
    v_add_u32 v34, s54, v33
    s_mul_i32 s54, s40, 7168
    v_add_u32 v33, s54, v33
    global_load_dwordx2 v[36:37], v33, s[8:9]
    global_load_dwordx2 v[38:39], v34, s[8:9]
    global_load_dwordx2 v[40:41], v33, s[10:11]
    global_load_dwordx2 v[42:43], v34, s[10:11]
    s_add_u32 s52, s52, 57344
    s_add_u32 s53, s53, 57344
    buffer_load_dwordx4 v[72:75], v32, s[36:39], s52 offen nt
    buffer_load_dwordx4 v[76:79], v32, s[36:39], s53 offen nt
    s_add_u32 s52, s52, 57344
    s_add_u32 s53, s53, 57344
    buffer_load_dwordx4 v[80:83], v32, s[36:39], s52 offen nt
    buffer_load_dwordx4 v[84:87], v32, s[36:39], s53 offen nt
    s_add_u32 s52, s52, 57344
    s_add_u32 s53, s53, 57344
    buffer_load_dwordx4 v[88:91], v32, s[36:39], s52 offen nt
    buffer_load_dwordx4 v[92:95], v32, s[36:39], s53 offen nt
    s_add_u32 s52, s52, 57344
    s_add_u32 s53, s53, 57344
    buffer_load_dwordx4 v[96:99], v32, s[36:39], s52 offen nt
    buffer_load_dwordx4 v[100:103], v32, s[36:39], s53 offen nt
    s_add_u32 s52, s52, 57344
    s_add_u32 s53, s53, 57344
    buffer_load_dwordx4 v[104:107], v32, s[36:39], s52 offen nt
    buffer_load_dwordx4 v[108:111], v32, s[36:39], s53 offen nt
    s_add_u32 s52, s52, 57344
    s_add_u32 s53, s53, 57344
    buffer_load_dwordx4 v[112:115], v32, s[36:39], s52 offen nt
    buffer_load_dwordx4 v[116:119], v32, s[36:39], s53 offen nt
    s_add_u32 s52, s52, 57344
    s_add_u32 s53, s53, 57344
    buffer_load_dwordx4 v[120:123], v32, s[36:39], s52 offen nt
    buffer_load_dwordx4 v[124:127], v32, s[36:39], s53 offen nt
    v_lshrrev_b32 v5, 1, v3
    v_lshrrev_b32 v6, 5, v2
    v_xor_b32 v5, v5, v6
    v_lshlrev_b32 v5, 4, v5
    v_lshl_add_u32 v5, v4, 7, v5
    v_and_b32 v6, 1, v2
    v_lshl_add_u32 v44, v6, 3, v5
    s_lshl_b32 s53, s43, 12
    v_add_u32 v44, s53, v44
    v_xor_b32 v45, 32, v44
    v_xor_b32 v46, 64, v44
    v_xor_b32 v47, 0x60, v44
    v_add_u32 v28, 98304, v44
    v_add_u32 v29, 98304, v45
    v_add_u32 v30, 98304, v46
    v_add_u32 v31, 98304, v47
    s_mul_i32 s52, s40, 56
    s_add_u32 s52, s52, s68
    s_lshl_b32 s52, s52, 14
    s_add_u32 s52, s52, 0
    s_mul_i32 s53, s69, 56
    s_add_u32 s53, s53, s68
    s_lshl_b32 s53, s53, 14
    s_add_u32 s53, s53, 0
    s_waitcnt vmcnt(14)
    v_lshlrev_b32 v48, 16, v36
    v_and_b32 v49, 0xffff0000, v36
    v_lshlrev_b32 v56, 16, v40
    v_and_b32 v57, 0xffff0000, v40
    v_lshlrev_b32 v50, 16, v37
    v_and_b32 v51, 0xffff0000, v37
    v_lshlrev_b32 v58, 16, v41
    v_and_b32 v59, 0xffff0000, v41
    v_lshlrev_b32 v52, 16, v38
    v_and_b32 v53, 0xffff0000, v38
    v_lshlrev_b32 v60, 16, v42
    v_and_b32 v61, 0xffff0000, v42
    v_lshlrev_b32 v54, 16, v39
    v_and_b32 v55, 0xffff0000, v39
    v_lshlrev_b32 v62, 16, v43
    v_and_b32 v63, 0xffff0000, v43
    v_cvt_f32_i32 v64, v64
    v_cvt_f32_i32 v65, v65
    v_cvt_f32_i32 v66, v66
    v_cvt_f32_i32 v67, v67
    v_cvt_f32_i32 v68, v68
    v_cvt_f32_i32 v69, v69
    v_cvt_f32_i32 v70, v70
    v_cvt_f32_i32 v71, v71
    v_cvt_pk_bf16_f32 v36, v64, v65
    v_cvt_pk_bf16_f32 v37, v66, v67
    v_cvt_pk_bf16_f32 v38, v68, v69
    v_cvt_pk_bf16_f32 v39, v70, v71
    v_lshlrev_b32 v64, 16, v36
    v_and_b32 v65, 0xffff0000, v36
    v_lshlrev_b32 v66, 16, v37
    v_and_b32 v67, 0xffff0000, v37
    v_lshlrev_b32 v68, 16, v38
    v_and_b32 v69, 0xffff0000, v38
    v_lshlrev_b32 v70, 16, v39
    v_and_b32 v71, 0xffff0000, v39
    v_sub_f32 v64, v64, v56
    v_sub_f32 v65, v65, v57
    v_sub_f32 v66, v66, v58
    v_sub_f32 v67, v67, v59
    v_sub_f32 v68, v68, v60
    v_sub_f32 v69, v69, v61
    v_sub_f32 v70, v70, v62
    v_sub_f32 v71, v71, v63
    v_cvt_pk_bf16_f32 v36, v64, v65
    v_cvt_pk_bf16_f32 v37, v66, v67
    v_cvt_pk_bf16_f32 v38, v68, v69
    v_cvt_pk_bf16_f32 v39, v70, v71
    v_lshlrev_b32 v64, 16, v36
    v_and_b32 v65, 0xffff0000, v36
    v_lshlrev_b32 v66, 16, v37
    v_and_b32 v67, 0xffff0000, v37
    v_lshlrev_b32 v68, 16, v38
    v_and_b32 v69, 0xffff0000, v38
    v_lshlrev_b32 v70, 16, v39
    v_and_b32 v71, 0xffff0000, v39
    v_mul_f32 v64, v64, v48
    v_mul_f32 v65, v65, v49
    v_mul_f32 v66, v66, v50
    v_mul_f32 v67, v67, v51
    v_mul_f32 v68, v68, v52
    v_mul_f32 v69, v69, v53
    v_mul_f32 v70, v70, v54
    v_mul_f32 v71, v71, v55
    v_cvt_pk_bf16_f32 v128, v64, v65
    v_cvt_pk_bf16_f32 v129, v66, v67
    v_cvt_pk_bf16_f32 v130, v68, v69
    v_cvt_pk_bf16_f32 v131, v70, v71
    buffer_store_dwordx2 v[128:129], v44, s[32:35], s52 offen offset:0 sc1
    buffer_store_dwordx2 v[130:131], v44, s[32:35], s53 offen offset:0 sc1
    ds_write_b64 v44, v[128:129] offset:0
    ds_write_b64 v28, v[130:131] offset:0
    s_waitcnt vmcnt(14)
    v_cvt_f32_i32 v72, v72
    v_cvt_f32_i32 v73, v73
    v_cvt_f32_i32 v74, v74
    v_cvt_f32_i32 v75, v75
    v_cvt_f32_i32 v76, v76
    v_cvt_f32_i32 v77, v77
    v_cvt_f32_i32 v78, v78
    v_cvt_f32_i32 v79, v79
    v_cvt_pk_bf16_f32 v36, v72, v73
    v_cvt_pk_bf16_f32 v37, v74, v75
    v_cvt_pk_bf16_f32 v38, v76, v77
    v_cvt_pk_bf16_f32 v39, v78, v79
    v_lshlrev_b32 v72, 16, v36
    v_and_b32 v73, 0xffff0000, v36
    v_lshlrev_b32 v74, 16, v37
    v_and_b32 v75, 0xffff0000, v37
    v_lshlrev_b32 v76, 16, v38
    v_and_b32 v77, 0xffff0000, v38
    v_lshlrev_b32 v78, 16, v39
    v_and_b32 v79, 0xffff0000, v39
    v_sub_f32 v72, v72, v56
    v_sub_f32 v73, v73, v57
    v_sub_f32 v74, v74, v58
    v_sub_f32 v75, v75, v59
    v_sub_f32 v76, v76, v60
    v_sub_f32 v77, v77, v61
    v_sub_f32 v78, v78, v62
    v_sub_f32 v79, v79, v63
    v_cvt_pk_bf16_f32 v36, v72, v73
    v_cvt_pk_bf16_f32 v37, v74, v75
    v_cvt_pk_bf16_f32 v38, v76, v77
    v_cvt_pk_bf16_f32 v39, v78, v79
    v_lshlrev_b32 v72, 16, v36
    v_and_b32 v73, 0xffff0000, v36
    v_lshlrev_b32 v74, 16, v37
    v_and_b32 v75, 0xffff0000, v37
    v_lshlrev_b32 v76, 16, v38
    v_and_b32 v77, 0xffff0000, v38
    v_lshlrev_b32 v78, 16, v39
    v_and_b32 v79, 0xffff0000, v39
    v_mul_f32 v72, v72, v48
    v_mul_f32 v73, v73, v49
    v_mul_f32 v74, v74, v50
    v_mul_f32 v75, v75, v51
    v_mul_f32 v76, v76, v52
    v_mul_f32 v77, v77, v53
    v_mul_f32 v78, v78, v54
    v_mul_f32 v79, v79, v55
    v_cvt_pk_bf16_f32 v132, v72, v73
    v_cvt_pk_bf16_f32 v133, v74, v75
    v_cvt_pk_bf16_f32 v134, v76, v77
    v_cvt_pk_bf16_f32 v135, v78, v79
    buffer_store_dwordx2 v[132:133], v45, s[32:35], s52 offen offset:512 sc1
    buffer_store_dwordx2 v[134:135], v45, s[32:35], s53 offen offset:512 sc1
    ds_write_b64 v45, v[132:133] offset:512
    ds_write_b64 v29, v[134:135] offset:512
    s_waitcnt vmcnt(14)
    v_cvt_f32_i32 v80, v80
    v_cvt_f32_i32 v81, v81
    v_cvt_f32_i32 v82, v82
    v_cvt_f32_i32 v83, v83
    v_cvt_f32_i32 v84, v84
    v_cvt_f32_i32 v85, v85
    v_cvt_f32_i32 v86, v86
    v_cvt_f32_i32 v87, v87
    v_cvt_pk_bf16_f32 v36, v80, v81
    v_cvt_pk_bf16_f32 v37, v82, v83
    v_cvt_pk_bf16_f32 v38, v84, v85
    v_cvt_pk_bf16_f32 v39, v86, v87
    v_lshlrev_b32 v80, 16, v36
    v_and_b32 v81, 0xffff0000, v36
    v_lshlrev_b32 v82, 16, v37
    v_and_b32 v83, 0xffff0000, v37
    v_lshlrev_b32 v84, 16, v38
    v_and_b32 v85, 0xffff0000, v38
    v_lshlrev_b32 v86, 16, v39
    v_and_b32 v87, 0xffff0000, v39
    v_sub_f32 v80, v80, v56
    v_sub_f32 v81, v81, v57
    v_sub_f32 v82, v82, v58
    v_sub_f32 v83, v83, v59
    v_sub_f32 v84, v84, v60
    v_sub_f32 v85, v85, v61
    v_sub_f32 v86, v86, v62
    v_sub_f32 v87, v87, v63
    v_cvt_pk_bf16_f32 v36, v80, v81
    v_cvt_pk_bf16_f32 v37, v82, v83
    v_cvt_pk_bf16_f32 v38, v84, v85
    v_cvt_pk_bf16_f32 v39, v86, v87
    v_lshlrev_b32 v80, 16, v36
    v_and_b32 v81, 0xffff0000, v36
    v_lshlrev_b32 v82, 16, v37
    v_and_b32 v83, 0xffff0000, v37
    v_lshlrev_b32 v84, 16, v38
    v_and_b32 v85, 0xffff0000, v38
    v_lshlrev_b32 v86, 16, v39
    v_and_b32 v87, 0xffff0000, v39
    v_mul_f32 v80, v80, v48
    v_mul_f32 v81, v81, v49
    v_mul_f32 v82, v82, v50
    v_mul_f32 v83, v83, v51
    v_mul_f32 v84, v84, v52
    v_mul_f32 v85, v85, v53
    v_mul_f32 v86, v86, v54
    v_mul_f32 v87, v87, v55
    v_cvt_pk_bf16_f32 v136, v80, v81
    v_cvt_pk_bf16_f32 v137, v82, v83
    v_cvt_pk_bf16_f32 v138, v84, v85
    v_cvt_pk_bf16_f32 v139, v86, v87
    buffer_store_dwordx2 v[136:137], v46, s[32:35], s52 offen offset:1024 sc1
    buffer_store_dwordx2 v[138:139], v46, s[32:35], s53 offen offset:1024 sc1
    ds_write_b64 v46, v[136:137] offset:1024
    ds_write_b64 v30, v[138:139] offset:1024
    s_waitcnt vmcnt(14)
    v_cvt_f32_i32 v88, v88
    v_cvt_f32_i32 v89, v89
    v_cvt_f32_i32 v90, v90
    v_cvt_f32_i32 v91, v91
    v_cvt_f32_i32 v92, v92
    v_cvt_f32_i32 v93, v93
    v_cvt_f32_i32 v94, v94
    v_cvt_f32_i32 v95, v95
    v_cvt_pk_bf16_f32 v36, v88, v89
    v_cvt_pk_bf16_f32 v37, v90, v91
    v_cvt_pk_bf16_f32 v38, v92, v93
    v_cvt_pk_bf16_f32 v39, v94, v95
    v_lshlrev_b32 v88, 16, v36
    v_and_b32 v89, 0xffff0000, v36
    v_lshlrev_b32 v90, 16, v37
    v_and_b32 v91, 0xffff0000, v37
    v_lshlrev_b32 v92, 16, v38
    v_and_b32 v93, 0xffff0000, v38
    v_lshlrev_b32 v94, 16, v39
    v_and_b32 v95, 0xffff0000, v39
    v_sub_f32 v88, v88, v56
    v_sub_f32 v89, v89, v57
    v_sub_f32 v90, v90, v58
    v_sub_f32 v91, v91, v59
    v_sub_f32 v92, v92, v60
    v_sub_f32 v93, v93, v61
    v_sub_f32 v94, v94, v62
    v_sub_f32 v95, v95, v63
    v_cvt_pk_bf16_f32 v36, v88, v89
    v_cvt_pk_bf16_f32 v37, v90, v91
    v_cvt_pk_bf16_f32 v38, v92, v93
    v_cvt_pk_bf16_f32 v39, v94, v95
    v_lshlrev_b32 v88, 16, v36
    v_and_b32 v89, 0xffff0000, v36
    v_lshlrev_b32 v90, 16, v37
    v_and_b32 v91, 0xffff0000, v37
    v_lshlrev_b32 v92, 16, v38
    v_and_b32 v93, 0xffff0000, v38
    v_lshlrev_b32 v94, 16, v39
    v_and_b32 v95, 0xffff0000, v39
    v_mul_f32 v88, v88, v48
    v_mul_f32 v89, v89, v49
    v_mul_f32 v90, v90, v50
    v_mul_f32 v91, v91, v51
    v_mul_f32 v92, v92, v52
    v_mul_f32 v93, v93, v53
    v_mul_f32 v94, v94, v54
    v_mul_f32 v95, v95, v55
    v_cvt_pk_bf16_f32 v140, v88, v89
    v_cvt_pk_bf16_f32 v141, v90, v91
    v_cvt_pk_bf16_f32 v142, v92, v93
    v_cvt_pk_bf16_f32 v143, v94, v95
    buffer_store_dwordx2 v[140:141], v47, s[32:35], s52 offen offset:1536 sc1
    buffer_store_dwordx2 v[142:143], v47, s[32:35], s53 offen offset:1536 sc1
    ds_write_b64 v47, v[140:141] offset:1536
    ds_write_b64 v31, v[142:143] offset:1536
    s_waitcnt vmcnt(14)
    v_cvt_f32_i32 v96, v96
    v_cvt_f32_i32 v97, v97
    v_cvt_f32_i32 v98, v98
    v_cvt_f32_i32 v99, v99
    v_cvt_f32_i32 v100, v100
    v_cvt_f32_i32 v101, v101
    v_cvt_f32_i32 v102, v102
    v_cvt_f32_i32 v103, v103
    v_cvt_pk_bf16_f32 v36, v96, v97
    v_cvt_pk_bf16_f32 v37, v98, v99
    v_cvt_pk_bf16_f32 v38, v100, v101
    v_cvt_pk_bf16_f32 v39, v102, v103
    v_lshlrev_b32 v96, 16, v36
    v_and_b32 v97, 0xffff0000, v36
    v_lshlrev_b32 v98, 16, v37
    v_and_b32 v99, 0xffff0000, v37
    v_lshlrev_b32 v100, 16, v38
    v_and_b32 v101, 0xffff0000, v38
    v_lshlrev_b32 v102, 16, v39
    v_and_b32 v103, 0xffff0000, v39
    v_sub_f32 v96, v96, v56
    v_sub_f32 v97, v97, v57
    v_sub_f32 v98, v98, v58
    v_sub_f32 v99, v99, v59
    v_sub_f32 v100, v100, v60
    v_sub_f32 v101, v101, v61
    v_sub_f32 v102, v102, v62
    v_sub_f32 v103, v103, v63
    v_cvt_pk_bf16_f32 v36, v96, v97
    v_cvt_pk_bf16_f32 v37, v98, v99
    v_cvt_pk_bf16_f32 v38, v100, v101
    v_cvt_pk_bf16_f32 v39, v102, v103
    v_lshlrev_b32 v96, 16, v36
    v_and_b32 v97, 0xffff0000, v36
    v_lshlrev_b32 v98, 16, v37
    v_and_b32 v99, 0xffff0000, v37
    v_lshlrev_b32 v100, 16, v38
    v_and_b32 v101, 0xffff0000, v38
    v_lshlrev_b32 v102, 16, v39
    v_and_b32 v103, 0xffff0000, v39
    v_mul_f32 v96, v96, v48
    v_mul_f32 v97, v97, v49
    v_mul_f32 v98, v98, v50
    v_mul_f32 v99, v99, v51
    v_mul_f32 v100, v100, v52
    v_mul_f32 v101, v101, v53
    v_mul_f32 v102, v102, v54
    v_mul_f32 v103, v103, v55
    v_cvt_pk_bf16_f32 v144, v96, v97
    v_cvt_pk_bf16_f32 v145, v98, v99
    v_cvt_pk_bf16_f32 v146, v100, v101
    v_cvt_pk_bf16_f32 v147, v102, v103
    buffer_store_dwordx2 v[144:145], v44, s[32:35], s52 offen offset:2048 sc1
    buffer_store_dwordx2 v[146:147], v44, s[32:35], s53 offen offset:2048 sc1
    ds_write_b64 v44, v[144:145] offset:2048
    ds_write_b64 v28, v[146:147] offset:2048
    s_waitcnt vmcnt(14)
    v_cvt_f32_i32 v104, v104
    v_cvt_f32_i32 v105, v105
    v_cvt_f32_i32 v106, v106
    v_cvt_f32_i32 v107, v107
    v_cvt_f32_i32 v108, v108
    v_cvt_f32_i32 v109, v109
    v_cvt_f32_i32 v110, v110
    v_cvt_f32_i32 v111, v111
    v_cvt_pk_bf16_f32 v36, v104, v105
    v_cvt_pk_bf16_f32 v37, v106, v107
    v_cvt_pk_bf16_f32 v38, v108, v109
    v_cvt_pk_bf16_f32 v39, v110, v111
    v_lshlrev_b32 v104, 16, v36
    v_and_b32 v105, 0xffff0000, v36
    v_lshlrev_b32 v106, 16, v37
    v_and_b32 v107, 0xffff0000, v37
    v_lshlrev_b32 v108, 16, v38
    v_and_b32 v109, 0xffff0000, v38
    v_lshlrev_b32 v110, 16, v39
    v_and_b32 v111, 0xffff0000, v39
    v_sub_f32 v104, v104, v56
    v_sub_f32 v105, v105, v57
    v_sub_f32 v106, v106, v58
    v_sub_f32 v107, v107, v59
    v_sub_f32 v108, v108, v60
    v_sub_f32 v109, v109, v61
    v_sub_f32 v110, v110, v62
    v_sub_f32 v111, v111, v63
    v_cvt_pk_bf16_f32 v36, v104, v105
    v_cvt_pk_bf16_f32 v37, v106, v107
    v_cvt_pk_bf16_f32 v38, v108, v109
    v_cvt_pk_bf16_f32 v39, v110, v111
    v_lshlrev_b32 v104, 16, v36
    v_and_b32 v105, 0xffff0000, v36
    v_lshlrev_b32 v106, 16, v37
    v_and_b32 v107, 0xffff0000, v37
    v_lshlrev_b32 v108, 16, v38
    v_and_b32 v109, 0xffff0000, v38
    v_lshlrev_b32 v110, 16, v39
    v_and_b32 v111, 0xffff0000, v39
    v_mul_f32 v104, v104, v48
    v_mul_f32 v105, v105, v49
    v_mul_f32 v106, v106, v50
    v_mul_f32 v107, v107, v51
    v_mul_f32 v108, v108, v52
    v_mul_f32 v109, v109, v53
    v_mul_f32 v110, v110, v54
    v_mul_f32 v111, v111, v55
    v_cvt_pk_bf16_f32 v148, v104, v105
    v_cvt_pk_bf16_f32 v149, v106, v107
    v_cvt_pk_bf16_f32 v150, v108, v109
    v_cvt_pk_bf16_f32 v151, v110, v111
    buffer_store_dwordx2 v[148:149], v45, s[32:35], s52 offen offset:2560 sc1
    buffer_store_dwordx2 v[150:151], v45, s[32:35], s53 offen offset:2560 sc1
    ds_write_b64 v45, v[148:149] offset:2560
    ds_write_b64 v29, v[150:151] offset:2560
    s_waitcnt vmcnt(14)
    v_cvt_f32_i32 v112, v112
    v_cvt_f32_i32 v113, v113
    v_cvt_f32_i32 v114, v114
    v_cvt_f32_i32 v115, v115
    v_cvt_f32_i32 v116, v116
    v_cvt_f32_i32 v117, v117
    v_cvt_f32_i32 v118, v118
    v_cvt_f32_i32 v119, v119
    v_cvt_pk_bf16_f32 v36, v112, v113
    v_cvt_pk_bf16_f32 v37, v114, v115
    v_cvt_pk_bf16_f32 v38, v116, v117
    v_cvt_pk_bf16_f32 v39, v118, v119
    v_lshlrev_b32 v112, 16, v36
    v_and_b32 v113, 0xffff0000, v36
    v_lshlrev_b32 v114, 16, v37
    v_and_b32 v115, 0xffff0000, v37
    v_lshlrev_b32 v116, 16, v38
    v_and_b32 v117, 0xffff0000, v38
    v_lshlrev_b32 v118, 16, v39
    v_and_b32 v119, 0xffff0000, v39
    v_sub_f32 v112, v112, v56
    v_sub_f32 v113, v113, v57
    v_sub_f32 v114, v114, v58
    v_sub_f32 v115, v115, v59
    v_sub_f32 v116, v116, v60
    v_sub_f32 v117, v117, v61
    v_sub_f32 v118, v118, v62
    v_sub_f32 v119, v119, v63
    v_cvt_pk_bf16_f32 v36, v112, v113
    v_cvt_pk_bf16_f32 v37, v114, v115
    v_cvt_pk_bf16_f32 v38, v116, v117
    v_cvt_pk_bf16_f32 v39, v118, v119
    v_lshlrev_b32 v112, 16, v36
    v_and_b32 v113, 0xffff0000, v36
    v_lshlrev_b32 v114, 16, v37
    v_and_b32 v115, 0xffff0000, v37
    v_lshlrev_b32 v116, 16, v38
    v_and_b32 v117, 0xffff0000, v38
    v_lshlrev_b32 v118, 16, v39
    v_and_b32 v119, 0xffff0000, v39
    v_mul_f32 v112, v112, v48
    v_mul_f32 v113, v113, v49
    v_mul_f32 v114, v114, v50
    v_mul_f32 v115, v115, v51
    v_mul_f32 v116, v116, v52
    v_mul_f32 v117, v117, v53
    v_mul_f32 v118, v118, v54
    v_mul_f32 v119, v119, v55
    v_cvt_pk_bf16_f32 v152, v112, v113
    v_cvt_pk_bf16_f32 v153, v114, v115
    v_cvt_pk_bf16_f32 v154, v116, v117
    v_cvt_pk_bf16_f32 v155, v118, v119
    buffer_store_dwordx2 v[152:153], v46, s[32:35], s52 offen offset:3072 sc1
    buffer_store_dwordx2 v[154:155], v46, s[32:35], s53 offen offset:3072 sc1
    ds_write_b64 v46, v[152:153] offset:3072
    ds_write_b64 v30, v[154:155] offset:3072
    s_waitcnt vmcnt(14)
    v_mov_b32 v10, 0
    global_load_dword v11, v10, s[18:19] sc1
    v_cvt_f32_i32 v120, v120
    v_cvt_f32_i32 v121, v121
    v_cvt_f32_i32 v122, v122
    v_cvt_f32_i32 v123, v123
    v_cvt_f32_i32 v124, v124
    v_cvt_f32_i32 v125, v125
    v_cvt_f32_i32 v126, v126
    v_cvt_f32_i32 v127, v127
    v_cvt_pk_bf16_f32 v36, v120, v121
    v_cvt_pk_bf16_f32 v37, v122, v123
    v_cvt_pk_bf16_f32 v38, v124, v125
    v_cvt_pk_bf16_f32 v39, v126, v127
    v_lshlrev_b32 v120, 16, v36
    v_and_b32 v121, 0xffff0000, v36
    v_lshlrev_b32 v122, 16, v37
    v_and_b32 v123, 0xffff0000, v37
    v_lshlrev_b32 v124, 16, v38
    v_and_b32 v125, 0xffff0000, v38
    v_lshlrev_b32 v126, 16, v39
    v_and_b32 v127, 0xffff0000, v39
    v_sub_f32 v120, v120, v56
    v_sub_f32 v121, v121, v57
    v_sub_f32 v122, v122, v58
    v_sub_f32 v123, v123, v59
    v_sub_f32 v124, v124, v60
    v_sub_f32 v125, v125, v61
    v_sub_f32 v126, v126, v62
    v_sub_f32 v127, v127, v63
    v_cvt_pk_bf16_f32 v36, v120, v121
    v_cvt_pk_bf16_f32 v37, v122, v123
    v_cvt_pk_bf16_f32 v38, v124, v125
    v_cvt_pk_bf16_f32 v39, v126, v127
    v_lshlrev_b32 v120, 16, v36
    v_and_b32 v121, 0xffff0000, v36
    v_lshlrev_b32 v122, 16, v37
    v_and_b32 v123, 0xffff0000, v37
    v_lshlrev_b32 v124, 16, v38
    v_and_b32 v125, 0xffff0000, v38
    v_lshlrev_b32 v126, 16, v39
    v_and_b32 v127, 0xffff0000, v39
    v_mul_f32 v120, v120, v48
    v_mul_f32 v121, v121, v49
    v_mul_f32 v122, v122, v50
    v_mul_f32 v123, v123, v51
    v_mul_f32 v124, v124, v52
    v_mul_f32 v125, v125, v53
    v_mul_f32 v126, v126, v54
    v_mul_f32 v127, v127, v55
    v_cvt_pk_bf16_f32 v156, v120, v121
    v_cvt_pk_bf16_f32 v157, v122, v123
    v_cvt_pk_bf16_f32 v158, v124, v125
    v_cvt_pk_bf16_f32 v159, v126, v127
    buffer_store_dwordx2 v[156:157], v47, s[32:35], s52 offen offset:3584 sc1
    buffer_store_dwordx2 v[158:159], v47, s[32:35], s53 offen offset:3584 sc1
    ds_write_b64 v47, v[156:157] offset:3584
    ds_write_b64 v31, v[158:159] offset:3584
    s_barrier
    s_branch L_quip_kernel_A2c
L_quip_kernel_A2l:
    s_mov_b32 s61, s73
    s_cmp_eq_u32 s74, 0
    s_cselect_b32 s68, 1, -1
    s_mul_i32 s68, s68, 3670016
    s_setprio 3
    s_mov_b32 s24, s20
    s_mov_b32 s25, s21
    s_mov_b32 s26, 268435456
    s_mov_b32 s27, 0x20000
    s_mov_b32 s28, s14
    s_mov_b32 s29, s15
    s_mov_b32 s30, 25690112
    s_mov_b32 s31, 0x20000
    v_lshlrev_b32 v16, 4, v2
    s_mul_i32 s46, s40, 917504
    s_mul_i32 s52, s59, 4096
    s_add_u32 s52, s52, 0
    s_add_u32 s46, s46, s52
    v_mul_u32_u24 v5, 7168, v4
    v_lshlrev_b32 v6, 1, v4
    v_xor_b32 v6, v6, v3
    v_lshl_add_u32 v7, v6, 4, v5
    v_xor_b32 v6, 8, v6
    v_lshl_add_u32 v8, v6, 4, v5
    v_add_u32 v20, 0, v7
    v_add_u32 v21, 27648, v7
    v_add_u32 v22, 55296, v8
    v_add_u32 v23, 82944, v8
    s_lshl_b32 s47, s41, 8
    s_mul_i32 s52, s59, 114688
    s_add_u32 s47, s47, s52
    s_mul_i32 s50, s59, 4096
    s_add_u32 s50, s50, 0
    s_mul_i32 s51, s59, 4096
    s_add_u32 s51, s51, 49152
    s_add_u32 s57, s50, 49152
    s_add_u32 s58, s42, 20
    s_mov_b32 s54, 0
    s_mov_b32 s60, 0
    s_add_u32 s55, s50, 0
    s_add_u32 s56, s51, 0
    s_mov_b32 s52, s61
    s_mov_b32 s69, s74
    s_cmp_eq_u32 s54, 0
    s_cbranch_scc1 L_ord1_d
    s_cmp_ge_u32 s54, 24
    s_cbranch_scc1 L_ord1_m
L_ord1:
    s_sub_u32 s52, s60, 1
    s_and_b32 s53, s52, 3
    s_cmp_eq_u32 s53, s42
    s_cselect_b32 s53, 4, 0
    s_cmp_ge_u32 s52, s58
    s_cselect_b32 s53, 1, s53
    s_add_u32 s52, s52, s53
    s_cmp_eq_u32 s60, 0
    s_cselect_b32 s52, s42, s52
    s_mov_b32 s89, s53
    s_add_u32 s52, s52, s75

    s_add_u32 s60, s60, 1
    s_cmp_eq_u32 s52, s61
    s_cbranch_scc1 L_ord1
    s_branch L_ord1_d
L_ord1_m:
    s_sub_u32 s52, s54, 25
    s_and_b32 s53, s52, 3
    s_cmp_eq_u32 s53, s42
    s_cselect_b32 s53, 4, 0
    s_sub_u32 s60, s52, 4
    s_cmp_ge_i32 s60, s42
    s_cselect_b32 s53, 1, s53
    s_add_u32 s52, s52, s53
    s_cmp_eq_u32 s54, 24
    s_cselect_b32 s52, s42, s52
    s_lshr_b32 s53, s52, 2
    s_and_b32 s53, s53, 1
    s_xor_b32 s69, s69, s53
    s_and_b32 s52, s52, 3
    s_cmp_eq_u32 s75, 0
    s_cselect_b32 s53, 24, 0
    s_add_u32 s52, s52, s53
L_ord1_d:
    s_mov_b32 s64, s52
    s_mul_i32 s69, s69, 28
    s_add_u32 s52, s52, s69
    s_mul_i32 s62, s52, 16384
    s_add_u32 s62, s62, s46
    s_mul_i32 s63, s52, 458752
    s_add_u32 s63, s63, s47
    s_lshl_b32 s52, s40, 9
    s_lshr_b32 s53, s66, 1
    s_lshl_b32 s53, s53, 7
    s_add_u32 s52, s52, s53
    s_add_u32 s52, s52, 22020096
    s_lshl_b32 s53, s41, 7
    s_add_u32 s53, s53, 22085632
    s_cmp_eq_u32 s59, 1
    s_cselect_b32 s52, s53, s52
    s_lshl_b32 s53, s41, 3
    s_add_u32 s53, s53, s40
    s_lshl_b32 s53, s53, 7
    s_add_u32 s53, s53, 22216704
    s_cmp_eq_u32 s59, 2
    s_cselect_b32 s52, s53, s52
    s_lshl_b32 s53, s40, 7
    s_add_u32 s53, s53, 22151168
    s_cmp_eq_u32 s59, 3
    s_cselect_b32 s52, s53, s52
    v_mov_b32 v24, 0
    buffer_load_dword v29, v24, s[32:35], s52 offen sc1
    v_mov_b32 v24, 0
    s_mov_b32 s71, 0
L_noncea2:
    global_load_dword v25, v24, s[18:19] sc1
    s_add_u32 s71, s71, 1
    s_waitcnt vmcnt(0)
    v_readfirstlane_b32 s65, v25
    s_cmp_gt_u32 s71, 65536
    s_cbranch_scc1 L_noncea2_ok
    s_cmp_eq_u32 s65, 0
    s_cbranch_scc1 L_noncea2
L_noncea2_ok:
    s_lshl_b32 s52, s40, 9
    s_add_u32 s52, s52, 22020096
    v_and_b32 v26, 31, v2
    v_min_u32 v26, 27, v26
    v_mul_u32_u24 v28, 37, v26
    v_lshrrev_b32 v28, 8, v28
    v_mul_u32_u24 v28, 25, v28
    v_add_u32 v26, v26, v28
    v_lshl_add_u32 v26, v26, 2, s52
    v_and_b32 v28, 32, v2
    v_lshlrev_b32 v28, 6, v28
    v_xor_b32 v26, v26, v28
    v_min_u32 v31, 6, v2
    v_lshl_add_u32 v31, v31, 2, s52
    s_mov_b32 s90, 0
    s_lshl_b32 s52, s40, 7
    s_add_u32 s52, s52, 22151104
    v_lshl_add_u32 v27, v2, 2, s52
    s_lshl_b32 s52, s41, 7
    s_add_u32 s52, s52, 22085632
    v_and_b32 v28, 7, v2
    v_lshl_add_u32 v28, v28, 2, s52
    v_cmp_gt_u32 vcc, 16, v2
    s_lshl_b32 s52, s41, 3
    s_add_u32 s52, s52, s40
    v_cndmask_b32 v27, v27, v28, vcc
    s_xor_b32 s52, s52, 4
    s_lshl_b32 s52, s52, 7
    s_add_u32 s52, s52, 22216704
    v_mov_b32 v28, s52
    v_cmp_le_u32 vcc, 48, v2
    s_mov_b32 s72, 0xf0000
    s_mov_b32 s73, 0
    v_cndmask_b32 v27, v27, v28, vcc
    s_barrier
    s_mov_b32 s48, s62
    s_mov_b32 s49, s63
    s_mov_b32 s70, s55
    s_mov_b32 s71, s56
    s_mov_b32 m0, s71
    s_nop 0
    buffer_load_dwordx4 v20, s[28:31], s49 offen offset:0  lds
    buffer_load_dwordx4 v21, s[28:31], s49 offen offset:1024  lds
    s_add_u32 s54, s54, 1
    s_mov_b32 s52, s61
    s_mov_b32 s69, s74
    s_cmp_eq_u32 s54, 0
    s_cbranch_scc1 L_ord2_d
    s_cmp_ge_u32 s54, 24
    s_cbranch_scc1 L_ord2_m
L_ord2:
    s_sub_u32 s52, s60, 1
    s_and_b32 s53, s52, 3
    s_cmp_eq_u32 s53, s42
    s_cselect_b32 s53, 4, 0
    s_cmp_ge_u32 s52, s58
    s_cselect_b32 s53, 1, s53
    s_add_u32 s52, s52, s53
    s_cmp_eq_u32 s60, 0
    s_cselect_b32 s52, s42, s52
    s_mov_b32 s89, s53
    s_add_u32 s52, s52, s75

    s_add_u32 s60, s60, 1
    s_cmp_eq_u32 s52, s61
    s_cbranch_scc1 L_ord2
    s_branch L_ord2_d
L_ord2_m:
    s_sub_u32 s52, s54, 25
    s_and_b32 s53, s52, 3
    s_cmp_eq_u32 s53, s42
    s_cselect_b32 s53, 4, 0
    s_sub_u32 s60, s52, 4
    s_cmp_ge_i32 s60, s42
    s_cselect_b32 s53, 1, s53
    s_add_u32 s52, s52, s53
    s_cmp_eq_u32 s54, 24
    s_cselect_b32 s52, s42, s52
    s_lshr_b32 s53, s52, 2
    s_and_b32 s53, s53, 1
    s_xor_b32 s69, s69, s53
    s_and_b32 s52, s52, 3
    s_cmp_eq_u32 s75, 0
    s_cselect_b32 s53, 24, 0
    s_add_u32 s52, s52, s53
L_ord2_d:
    s_mov_b32 s64, s52
    s_mul_i32 s69, s69, 28
    s_add_u32 s52, s52, s69
    s_mul_i32 s62, s52, 16384
    s_add_u32 s62, s62, s46
    s_mul_i32 s63, s52, 458752
    s_add_u32 s63, s63, s47
    buffer_load_dwordx4 v22, s[28:31], s49 offen offset:2048  lds
    s_add_u32 s55, s55, 16384
    s_add_u32 s56, s56, 16384
    s_cmp_eq_u32 s55, s57
    s_cselect_b32 s55, s50, s55
    s_cselect_b32 s56, s51, s56
    buffer_load_dwordx4 v23, s[28:31], s49 offen offset:3072  lds
    s_mov_b32 s94, s54
    s_mov_b32 s95, s60
    s_mov_b32 s96, s55
    s_mov_b32 s97, s56
    s_mov_b32 s98, s62
    s_mov_b32 s99, s63
    s_mov_b32 s100, s64
    s_mov_b32 s48, s62
    s_mov_b32 s49, s63
    s_mov_b32 s70, s55
    s_mov_b32 s71, s56
    s_mov_b32 m0, s71
    s_nop 0
    buffer_load_dwordx4 v20, s[28:31], s49 offen offset:0  lds
    buffer_load_dwordx4 v21, s[28:31], s49 offen offset:1024  lds
    s_add_u32 s54, s54, 1
    s_mov_b32 s52, s61
    s_mov_b32 s69, s74
    s_cmp_eq_u32 s54, 0
    s_cbranch_scc1 L_ord3_d
    s_cmp_ge_u32 s54, 24
    s_cbranch_scc1 L_ord3_m
L_ord3:
    s_sub_u32 s52, s60, 1
    s_and_b32 s53, s52, 3
    s_cmp_eq_u32 s53, s42
    s_cselect_b32 s53, 4, 0
    s_cmp_ge_u32 s52, s58
    s_cselect_b32 s53, 1, s53
    s_add_u32 s52, s52, s53
    s_cmp_eq_u32 s60, 0
    s_cselect_b32 s52, s42, s52
    s_mov_b32 s89, s53
    s_add_u32 s52, s52, s75

    s_add_u32 s60, s60, 1
    s_cmp_eq_u32 s52, s61
    s_cbranch_scc1 L_ord3
    s_branch L_ord3_d
L_ord3_m:
    s_sub_u32 s52, s54, 25
    s_and_b32 s53, s52, 3
    s_cmp_eq_u32 s53, s42
    s_cselect_b32 s53, 4, 0
    s_sub_u32 s60, s52, 4
    s_cmp_ge_i32 s60, s42
    s_cselect_b32 s53, 1, s53
    s_add_u32 s52, s52, s53
    s_cmp_eq_u32 s54, 24
    s_cselect_b32 s52, s42, s52
    s_lshr_b32 s53, s52, 2
    s_and_b32 s53, s53, 1
    s_xor_b32 s69, s69, s53
    s_and_b32 s52, s52, 3
    s_cmp_eq_u32 s75, 0
    s_cselect_b32 s53, 24, 0
    s_add_u32 s52, s52, s53
L_ord3_d:
    s_mov_b32 s64, s52
    s_mul_i32 s69, s69, 28
    s_add_u32 s52, s52, s69
    s_mul_i32 s62, s52, 16384
    s_add_u32 s62, s62, s46
    s_mul_i32 s63, s52, 458752
    s_add_u32 s63, s63, s47
    buffer_load_dwordx4 v22, s[28:31], s49 offen offset:2048  lds
    s_add_u32 s55, s55, 16384
    s_add_u32 s56, s56, 16384
    s_cmp_eq_u32 s55, s57
    s_cselect_b32 s55, s50, s55
    s_cselect_b32 s56, s51, s56
    buffer_load_dwordx4 v23, s[28:31], s49 offen offset:3072  lds
    s_barrier
    s_waitcnt vmcnt(4)
    s_barrier
    s_mov_b32 s54, s94
    s_mov_b32 s60, s95
    s_mov_b32 s55, s96
    s_mov_b32 s56, s97
    s_mov_b32 s62, s98
    s_mov_b32 s63, s99
    s_mov_b32 s64, s100
    s_bitcmp1_b32 s90, s64
    s_cbranch_scc1 L_ep4_ok
    s_mul_i32 s52, s64, 37
    s_lshr_b32 s52, s52, 8
    s_lshl_b32 s53, s52, 7
    s_mul_i32 s52, s52, 7
    s_mov_b32 s71, 0
L_ep4:
    buffer_load_dword v25, v31, s[32:35], s53 offen sc1
    s_add_u32 s71, s71, 1
    s_waitcnt vmcnt(0)
    v_cmp_eq_u32 vcc, s65, v25
    s_and_b32 s70, vcc_lo, 0x7f
    s_lshl_b32 s70, s70, s52
    s_or_b32 s90, s90, s70
    s_bitcmp1_b32 s90, s64
    s_cbranch_scc1 L_ep4_ok
    s_sleep 2
    s_cmp_lt_u32 s71, 65536
    s_cbranch_scc1 L_ep4
L_ep4_ok:
    s_mov_b32 s48, s62
    s_mov_b32 s49, s63
    s_mov_b32 s70, s55
    s_mov_b32 s71, s56
    s_mov_b32 m0, s70
    s_nop 0
    buffer_load_dwordx4 v16, s[24:27], s48 offen offset:0 sc1 lds
    buffer_load_dwordx4 v16, s[24:27], s48 offen offset:1024 sc1 lds
    s_add_u32 s54, s54, 1
    s_mov_b32 s52, s61
    s_mov_b32 s69, s74
    s_cmp_eq_u32 s54, 0
    s_cbranch_scc1 L_ord5_d
    s_cmp_ge_u32 s54, 24
    s_cbranch_scc1 L_ord5_m
L_ord5:
    s_sub_u32 s52, s60, 1
    s_and_b32 s53, s52, 3
    s_cmp_eq_u32 s53, s42
    s_cselect_b32 s53, 4, 0
    s_cmp_ge_u32 s52, s58
    s_cselect_b32 s53, 1, s53
    s_add_u32 s52, s52, s53
    s_cmp_eq_u32 s60, 0
    s_cselect_b32 s52, s42, s52
    s_mov_b32 s89, s53
    s_add_u32 s52, s52, s75

    s_add_u32 s60, s60, 1
    s_cmp_eq_u32 s52, s61
    s_cbranch_scc1 L_ord5
    s_branch L_ord5_d
L_ord5_m:
    s_sub_u32 s52, s54, 25
    s_and_b32 s53, s52, 3
    s_cmp_eq_u32 s53, s42
    s_cselect_b32 s53, 4, 0
    s_sub_u32 s60, s52, 4
    s_cmp_ge_i32 s60, s42
    s_cselect_b32 s53, 1, s53
    s_add_u32 s52, s52, s53
    s_cmp_eq_u32 s54, 24
    s_cselect_b32 s52, s42, s52
    s_lshr_b32 s53, s52, 2
    s_and_b32 s53, s53, 1
    s_xor_b32 s69, s69, s53
    s_and_b32 s52, s52, 3
    s_cmp_eq_u32 s75, 0
    s_cselect_b32 s53, 24, 0
    s_add_u32 s52, s52, s53
L_ord5_d:
    s_mov_b32 s64, s52
    s_mul_i32 s69, s69, 28
    s_add_u32 s52, s52, s69
    s_mul_i32 s62, s52, 16384
    s_add_u32 s62, s62, s46
    s_mul_i32 s63, s52, 458752
    s_add_u32 s63, s63, s47
    buffer_load_dwordx4 v16, s[24:27], s48 offen offset:2048 sc1 lds
    s_add_u32 s55, s55, 16384
    s_add_u32 s56, s56, 16384
    s_cmp_eq_u32 s55, s57
    s_cselect_b32 s55, s50, s55
    s_cselect_b32 s56, s51, s56
    buffer_load_dwordx4 v16, s[24:27], s48 offen offset:3072 sc1 lds
    s_add_u32 m0, s70, 98304
    s_add_u32 s48, s48, s68
    buffer_load_dwordx4 v16, s[24:27], s48 offen offset:0 sc1 lds
    buffer_load_dwordx4 v16, s[24:27], s48 offen offset:1024 sc1 lds
    buffer_load_dwordx4 v16, s[24:27], s48 offen offset:2048 sc1 lds
    buffer_load_dwordx4 v16, s[24:27], s48 offen offset:3072 sc1 lds
    s_bitcmp1_b32 s90, s64
    s_cbranch_scc1 L_ep6_ok
    s_mul_i32 s52, s64, 37
    s_lshr_b32 s52, s52, 8
    s_lshl_b32 s53, s52, 7
    s_mul_i32 s52, s52, 7
    s_mov_b32 s71, 0
L_ep6:
    buffer_load_dword v25, v31, s[32:35], s53 offen sc1
    s_add_u32 s71, s71, 1
    s_waitcnt vmcnt(0)
    v_cmp_eq_u32 vcc, s65, v25
    s_and_b32 s70, vcc_lo, 0x7f
    s_lshl_b32 s70, s70, s52
    s_or_b32 s90, s90, s70
    s_bitcmp1_b32 s90, s64
    s_cbranch_scc1 L_ep6_ok
    s_sleep 2
    s_cmp_lt_u32 s71, 65536
    s_cbranch_scc1 L_ep6
L_ep6_ok:
    s_mov_b32 s48, s62
    s_mov_b32 s49, s63
    s_mov_b32 s70, s55
    s_mov_b32 s71, s56
    s_mov_b32 m0, s71
    s_nop 0
    buffer_load_dwordx4 v20, s[28:31], s49 offen offset:0  lds
    buffer_load_dwordx4 v21, s[28:31], s49 offen offset:1024  lds
    s_add_u32 s54, s54, 1
    s_mov_b32 s52, s61
    s_mov_b32 s69, s74
    s_cmp_eq_u32 s54, 0
    s_cbranch_scc1 L_ord7_d
    s_cmp_ge_u32 s54, 24
    s_cbranch_scc1 L_ord7_m
L_ord7:
    s_sub_u32 s52, s60, 1
    s_and_b32 s53, s52, 3
    s_cmp_eq_u32 s53, s42
    s_cselect_b32 s53, 4, 0
    s_cmp_ge_u32 s52, s58
    s_cselect_b32 s53, 1, s53
    s_add_u32 s52, s52, s53
    s_cmp_eq_u32 s60, 0
    s_cselect_b32 s52, s42, s52
    s_mov_b32 s89, s53
    s_add_u32 s52, s52, s75

    s_add_u32 s60, s60, 1
    s_cmp_eq_u32 s52, s61
    s_cbranch_scc1 L_ord7
    s_branch L_ord7_d
L_ord7_m:
    s_sub_u32 s52, s54, 25
    s_and_b32 s53, s52, 3
    s_cmp_eq_u32 s53, s42
    s_cselect_b32 s53, 4, 0
    s_sub_u32 s60, s52, 4
    s_cmp_ge_i32 s60, s42
    s_cselect_b32 s53, 1, s53
    s_add_u32 s52, s52, s53
    s_cmp_eq_u32 s54, 24
    s_cselect_b32 s52, s42, s52
    s_lshr_b32 s53, s52, 2
    s_and_b32 s53, s53, 1
    s_xor_b32 s69, s69, s53
    s_and_b32 s52, s52, 3
    s_cmp_eq_u32 s75, 0
    s_cselect_b32 s53, 24, 0
    s_add_u32 s52, s52, s53
L_ord7_d:
    s_mov_b32 s64, s52
    s_mul_i32 s69, s69, 28
    s_add_u32 s52, s52, s69
    s_mul_i32 s62, s52, 16384
    s_add_u32 s62, s62, s46
    s_mul_i32 s63, s52, 458752
    s_add_u32 s63, s63, s47
    buffer_load_dwordx4 v22, s[28:31], s49 offen offset:2048  lds
    s_add_u32 s55, s55, 16384
    s_add_u32 s56, s56, 16384
    s_cmp_eq_u32 s55, s57
    s_cselect_b32 s55, s50, s55
    s_cselect_b32 s56, s51, s56
    buffer_load_dwordx4 v23, s[28:31], s49 offen offset:3072  lds
    s_mov_b32 m0, s70
    s_nop 0
    buffer_load_dwordx4 v16, s[24:27], s48 offen offset:0 sc1 lds
    buffer_load_dwordx4 v16, s[24:27], s48 offen offset:1024 sc1 lds
    buffer_load_dwordx4 v16, s[24:27], s48 offen offset:2048 sc1 lds
    buffer_load_dwordx4 v16, s[24:27], s48 offen offset:3072 sc1 lds
    s_add_u32 m0, s70, 98304
    s_add_u32 s48, s48, s68
    buffer_load_dwordx4 v16, s[24:27], s48 offen offset:0 sc1 lds
    buffer_load_dwordx4 v16, s[24:27], s48 offen offset:1024 sc1 lds
    buffer_load_dwordx4 v16, s[24:27], s48 offen offset:2048 sc1 lds
    buffer_load_dwordx4 v16, s[24:27], s48 offen offset:3072 sc1 lds
    s_waitcnt vmcnt(12)
    s_barrier
    s_bitcmp1_b32 s90, s64
    s_cbranch_scc1 L_ep8_ok
    s_mul_i32 s52, s64, 37
    s_lshr_b32 s52, s52, 8
    s_lshl_b32 s53, s52, 7
    s_mul_i32 s52, s52, 7
    s_mov_b32 s71, 0
L_ep8:
    buffer_load_dword v25, v31, s[32:35], s53 offen sc1
    s_add_u32 s71, s71, 1
    s_waitcnt vmcnt(0)
    v_cmp_eq_u32 vcc, s65, v25
    s_and_b32 s70, vcc_lo, 0x7f
    s_lshl_b32 s70, s70, s52
    s_or_b32 s90, s90, s70
    s_bitcmp1_b32 s90, s64
    s_cbranch_scc1 L_ep8_ok
    s_sleep 2
    s_cmp_lt_u32 s71, 65536
    s_cbranch_scc1 L_ep8
L_ep8_ok:
    s_mov_b32 s48, s62
    s_mov_b32 s49, s63
    s_mov_b32 s70, s55
    s_mov_b32 s71, s56
    s_mov_b32 m0, s71
    s_nop 0
    buffer_load_dwordx4 v20, s[28:31], s49 offen offset:0  lds
    buffer_load_dwordx4 v21, s[28:31], s49 offen offset:1024  lds
    s_add_u32 s54, s54, 1
    s_mov_b32 s52, s61
    s_mov_b32 s69, s74
    s_cmp_eq_u32 s54, 0
    s_cbranch_scc1 L_ord9_d
    s_cmp_ge_u32 s54, 24
    s_cbranch_scc1 L_ord9_m
L_ord9:
    s_sub_u32 s52, s60, 1
    s_and_b32 s53, s52, 3
    s_cmp_eq_u32 s53, s42
    s_cselect_b32 s53, 4, 0
    s_cmp_ge_u32 s52, s58
    s_cselect_b32 s53, 1, s53
    s_add_u32 s52, s52, s53
    s_cmp_eq_u32 s60, 0
    s_cselect_b32 s52, s42, s52
    s_mov_b32 s89, s53
    s_add_u32 s52, s52, s75

    s_add_u32 s60, s60, 1
    s_cmp_eq_u32 s52, s61
    s_cbranch_scc1 L_ord9
    s_branch L_ord9_d
L_ord9_m:
    s_sub_u32 s52, s54, 25
    s_and_b32 s53, s52, 3
    s_cmp_eq_u32 s53, s42
    s_cselect_b32 s53, 4, 0
    s_sub_u32 s60, s52, 4
    s_cmp_ge_i32 s60, s42
    s_cselect_b32 s53, 1, s53
    s_add_u32 s52, s52, s53
    s_cmp_eq_u32 s54, 24
    s_cselect_b32 s52, s42, s52
    s_lshr_b32 s53, s52, 2
    s_and_b32 s53, s53, 1
    s_xor_b32 s69, s69, s53
    s_and_b32 s52, s52, 3
    s_cmp_eq_u32 s75, 0
    s_cselect_b32 s53, 24, 0
    s_add_u32 s52, s52, s53
L_ord9_d:
    s_mov_b32 s64, s52
    s_mul_i32 s69, s69, 28
    s_add_u32 s52, s52, s69
    s_mul_i32 s62, s52, 16384
    s_add_u32 s62, s62, s46
    s_mul_i32 s63, s52, 458752
    s_add_u32 s63, s63, s47
    buffer_load_dwordx4 v22, s[28:31], s49 offen offset:2048  lds
    s_add_u32 s55, s55, 16384
    s_add_u32 s56, s56, 16384
    s_cmp_eq_u32 s55, s57
    s_cselect_b32 s55, s50, s55
    s_cselect_b32 s56, s51, s56
    buffer_load_dwordx4 v23, s[28:31], s49 offen offset:3072  lds
    s_mov_b32 m0, s70
    s_nop 0
    buffer_load_dwordx4 v16, s[24:27], s48 offen offset:0 sc1 lds
    buffer_load_dwordx4 v16, s[24:27], s48 offen offset:1024 sc1 lds
    buffer_load_dwordx4 v16, s[24:27], s48 offen offset:2048 sc1 lds
    buffer_load_dwordx4 v16, s[24:27], s48 offen offset:3072 sc1 lds
    s_add_u32 m0, s70, 98304
    s_add_u32 s48, s48, s68
    buffer_load_dwordx4 v16, s[24:27], s48 offen offset:0 sc1 lds
    buffer_load_dwordx4 v16, s[24:27], s48 offen offset:1024 sc1 lds
    buffer_load_dwordx4 v16, s[24:27], s48 offen offset:2048 sc1 lds
    buffer_load_dwordx4 v16, s[24:27], s48 offen offset:3072 sc1 lds
    s_waitcnt vmcnt(12)
    s_barrier
    s_bitcmp1_b32 s90, s64
    s_cbranch_scc1 L_ep10_ok
    s_mul_i32 s52, s64, 37
    s_lshr_b32 s52, s52, 8
    s_lshl_b32 s53, s52, 7
    s_mul_i32 s52, s52, 7
    s_mov_b32 s71, 0
L_ep10:
    buffer_load_dword v25, v31, s[32:35], s53 offen sc1
    s_add_u32 s71, s71, 1
    s_waitcnt vmcnt(0)
    v_cmp_eq_u32 vcc, s65, v25
    s_and_b32 s70, vcc_lo, 0x7f
    s_lshl_b32 s70, s70, s52
    s_or_b32 s90, s90, s70
    s_bitcmp1_b32 s90, s64
    s_cbranch_scc1 L_ep10_ok
    s_sleep 2
    s_cmp_lt_u32 s71, 65536
    s_cbranch_scc1 L_ep10
L_ep10_ok:
    s_mov_b32 s48, s62
    s_mov_b32 s49, s63
    s_mov_b32 s70, s55
    s_mov_b32 s71, s56
    s_mov_b32 m0, s71
    s_nop 0
    buffer_load_dwordx4 v20, s[28:31], s49 offen offset:0  lds
    buffer_load_dwordx4 v21, s[28:31], s49 offen offset:1024  lds
    s_add_u32 s54, s54, 1
    s_mov_b32 s52, s61
    s_mov_b32 s69, s74
    s_cmp_eq_u32 s54, 0
    s_cbranch_scc1 L_ord11_d
    s_cmp_ge_u32 s54, 24
    s_cbranch_scc1 L_ord11_m
L_ord11:
    s_sub_u32 s52, s60, 1
    s_and_b32 s53, s52, 3
    s_cmp_eq_u32 s53, s42
    s_cselect_b32 s53, 4, 0
    s_cmp_ge_u32 s52, s58
    s_cselect_b32 s53, 1, s53
    s_add_u32 s52, s52, s53
    s_cmp_eq_u32 s60, 0
    s_cselect_b32 s52, s42, s52
    s_mov_b32 s89, s53
    s_add_u32 s52, s52, s75

    s_add_u32 s60, s60, 1
    s_cmp_eq_u32 s52, s61
    s_cbranch_scc1 L_ord11
    s_branch L_ord11_d
L_ord11_m:
    s_sub_u32 s52, s54, 25
    s_and_b32 s53, s52, 3
    s_cmp_eq_u32 s53, s42
    s_cselect_b32 s53, 4, 0
    s_sub_u32 s60, s52, 4
    s_cmp_ge_i32 s60, s42
    s_cselect_b32 s53, 1, s53
    s_add_u32 s52, s52, s53
    s_cmp_eq_u32 s54, 24
    s_cselect_b32 s52, s42, s52
    s_lshr_b32 s53, s52, 2
    s_and_b32 s53, s53, 1
    s_xor_b32 s69, s69, s53
    s_and_b32 s52, s52, 3
    s_cmp_eq_u32 s75, 0
    s_cselect_b32 s53, 24, 0
    s_add_u32 s52, s52, s53
L_ord11_d:
    s_mov_b32 s64, s52
    s_mul_i32 s69, s69, 28
    s_add_u32 s52, s52, s69
    s_mul_i32 s62, s52, 16384
    s_add_u32 s62, s62, s46
    s_mul_i32 s63, s52, 458752
    s_add_u32 s63, s63, s47
    buffer_load_dwordx4 v22, s[28:31], s49 offen offset:2048  lds
    s_add_u32 s55, s55, 16384
    s_add_u32 s56, s56, 16384
    s_cmp_eq_u32 s55, s57
    s_cselect_b32 s55, s50, s55
    s_cselect_b32 s56, s51, s56
    buffer_load_dwordx4 v23, s[28:31], s49 offen offset:3072  lds
    s_mov_b32 m0, s70
    s_nop 0
    buffer_load_dwordx4 v16, s[24:27], s48 offen offset:0 sc1 lds
    buffer_load_dwordx4 v16, s[24:27], s48 offen offset:1024 sc1 lds
    buffer_load_dwordx4 v16, s[24:27], s48 offen offset:2048 sc1 lds
    buffer_load_dwordx4 v16, s[24:27], s48 offen offset:3072 sc1 lds
    s_add_u32 m0, s70, 98304
    s_add_u32 s48, s48, s68
    buffer_load_dwordx4 v16, s[24:27], s48 offen offset:0 sc1 lds
    buffer_load_dwordx4 v16, s[24:27], s48 offen offset:1024 sc1 lds
    buffer_load_dwordx4 v16, s[24:27], s48 offen offset:2048 sc1 lds
    buffer_load_dwordx4 v16, s[24:27], s48 offen offset:3072 sc1 lds
    s_waitcnt vmcnt(12)
    s_barrier
    s_bitcmp1_b32 s90, s64
    s_cbranch_scc1 L_ep12_ok
    s_mul_i32 s52, s64, 37
    s_lshr_b32 s52, s52, 8
    s_lshl_b32 s53, s52, 7
    s_mul_i32 s52, s52, 7
    s_mov_b32 s71, 0
L_ep12:
    buffer_load_dword v25, v31, s[32:35], s53 offen sc1
    s_add_u32 s71, s71, 1
    s_waitcnt vmcnt(0)
    v_cmp_eq_u32 vcc, s65, v25
    s_and_b32 s70, vcc_lo, 0x7f
    s_lshl_b32 s70, s70, s52
    s_or_b32 s90, s90, s70
    s_bitcmp1_b32 s90, s64
    s_cbranch_scc1 L_ep12_ok
    s_sleep 2
    s_cmp_lt_u32 s71, 65536
    s_cbranch_scc1 L_ep12
L_ep12_ok:
    buffer_load_dword v24, v26, s[32:35], 0 offen sc1
    s_mov_b32 s48, s62
    s_mov_b32 s49, s63
    s_mov_b32 s70, s55
    s_mov_b32 s71, s56
    s_mov_b32 m0, s71
    s_nop 0
    buffer_load_dwordx4 v20, s[28:31], s49 offen offset:0  lds
    buffer_load_dwordx4 v21, s[28:31], s49 offen offset:1024  lds
    s_add_u32 s54, s54, 1
    s_mov_b32 s52, s61
    s_mov_b32 s69, s74
    s_cmp_eq_u32 s54, 0
    s_cbranch_scc1 L_ord13_d
    s_cmp_ge_u32 s54, 24
    s_cbranch_scc1 L_ord13_m
L_ord13:
    s_sub_u32 s52, s60, 1
    s_and_b32 s53, s52, 3
    s_cmp_eq_u32 s53, s42
    s_cselect_b32 s53, 4, 0
    s_cmp_ge_u32 s52, s58
    s_cselect_b32 s53, 1, s53
    s_add_u32 s52, s52, s53
    s_cmp_eq_u32 s60, 0
    s_cselect_b32 s52, s42, s52
    s_mov_b32 s89, s53
    s_add_u32 s52, s52, s75

    s_add_u32 s60, s60, 1
    s_cmp_eq_u32 s52, s61
    s_cbranch_scc1 L_ord13
    s_branch L_ord13_d
L_ord13_m:
    s_sub_u32 s52, s54, 25
    s_and_b32 s53, s52, 3
    s_cmp_eq_u32 s53, s42
    s_cselect_b32 s53, 4, 0
    s_sub_u32 s60, s52, 4
    s_cmp_ge_i32 s60, s42
    s_cselect_b32 s53, 1, s53
    s_add_u32 s52, s52, s53
    s_cmp_eq_u32 s54, 24
    s_cselect_b32 s52, s42, s52
    s_lshr_b32 s53, s52, 2
    s_and_b32 s53, s53, 1
    s_xor_b32 s69, s69, s53
    s_and_b32 s52, s52, 3
    s_cmp_eq_u32 s75, 0
    s_cselect_b32 s53, 24, 0
    s_add_u32 s52, s52, s53
L_ord13_d:
    s_mov_b32 s64, s52
    s_mul_i32 s69, s69, 28
    s_add_u32 s52, s52, s69
    s_mul_i32 s62, s52, 16384
    s_add_u32 s62, s62, s46
    s_mul_i32 s63, s52, 458752
    s_add_u32 s63, s63, s47
    buffer_load_dwordx4 v22, s[28:31], s49 offen offset:2048  lds
    s_add_u32 s55, s55, 16384
    s_add_u32 s56, s56, 16384
    s_cmp_eq_u32 s55, s57
    s_cselect_b32 s55, s50, s55
    s_cselect_b32 s56, s51, s56
    buffer_load_dwordx4 v23, s[28:31], s49 offen offset:3072  lds
    s_mov_b32 m0, s70
    s_nop 0
    buffer_load_dwordx4 v16, s[24:27], s48 offen offset:0 sc1 lds
    buffer_load_dwordx4 v16, s[24:27], s48 offen offset:1024 sc1 lds
    buffer_load_dwordx4 v16, s[24:27], s48 offen offset:2048 sc1 lds
    buffer_load_dwordx4 v16, s[24:27], s48 offen offset:3072 sc1 lds
    s_add_u32 m0, s70, 98304
    s_add_u32 s48, s48, s68
    buffer_load_dwordx4 v16, s[24:27], s48 offen offset:0 sc1 lds
    buffer_load_dwordx4 v16, s[24:27], s48 offen offset:1024 sc1 lds
    buffer_load_dwordx4 v16, s[24:27], s48 offen offset:2048 sc1 lds
    buffer_load_dwordx4 v16, s[24:27], s48 offen offset:3072 sc1 lds
    s_waitcnt vmcnt(12)
    v_cmp_eq_u32 vcc, s65, v24
    s_or_b32 s90, s90, vcc_lo
    s_mov_b32 s91, vcc_hi
    s_barrier
.p2align 6
L_quip_kernel_go:
    s_bitcmp1_b32 s90, s64
    s_cbranch_scc1 L_ep14_ok
    s_mul_i32 s52, s64, 37
    s_lshr_b32 s52, s52, 8
    s_lshl_b32 s53, s52, 7
    s_mul_i32 s52, s52, 7
    s_mov_b32 s71, 0
L_ep14:
    buffer_load_dword v25, v31, s[32:35], s53 offen sc1
    s_add_u32 s71, s71, 1
    s_waitcnt vmcnt(0)
    v_cmp_eq_u32 vcc, s65, v25
    s_and_b32 s70, vcc_lo, 0x7f
    s_lshl_b32 s70, s70, s52
    s_or_b32 s90, s90, s70
    s_bitcmp1_b32 s90, s64
    s_cbranch_scc1 L_ep14_ok
    s_sleep 2
    s_cmp_lt_u32 s71, 65536
    s_cbranch_scc1 L_ep14
L_ep14_ok:
    s_mov_b32 s48, s62
    s_mov_b32 s49, s63
    s_mov_b32 s70, s55
    s_mov_b32 s71, s56
    s_mov_b32 m0, s71
    s_nop 0
    buffer_load_dwordx4 v20, s[28:31], s49 offen offset:0  lds
    buffer_load_dwordx4 v21, s[28:31], s49 offen offset:1024  lds
    s_add_u32 s54, s54, 1
    s_mov_b32 s52, s61
    s_mov_b32 s69, s74
    s_cmp_eq_u32 s54, 0
    s_cbranch_scc1 L_ord15_d
    s_cmp_ge_u32 s54, 24
    s_cbranch_scc1 L_ord15_m
L_ord15:
    s_sub_u32 s52, s60, 1
    s_and_b32 s53, s52, 3
    s_cmp_eq_u32 s53, s42
    s_cselect_b32 s53, 4, 0
    s_cmp_ge_u32 s52, s58
    s_cselect_b32 s53, 1, s53
    s_add_u32 s52, s52, s53
    s_cmp_eq_u32 s60, 0
    s_cselect_b32 s52, s42, s52
    s_mov_b32 s89, s53
    s_add_u32 s52, s52, s75

    s_add_u32 s60, s60, 1
    s_cmp_eq_u32 s52, s61
    s_cbranch_scc1 L_ord15
    s_branch L_ord15_d
L_ord15_m:
    s_sub_u32 s52, s54, 25
    s_and_b32 s53, s52, 3
    s_cmp_eq_u32 s53, s42
    s_cselect_b32 s53, 4, 0
    s_sub_u32 s60, s52, 4
    s_cmp_ge_i32 s60, s42
    s_cselect_b32 s53, 1, s53
    s_add_u32 s52, s52, s53
    s_cmp_eq_u32 s54, 24
    s_cselect_b32 s52, s42, s52
    s_lshr_b32 s53, s52, 2
    s_and_b32 s53, s53, 1
    s_xor_b32 s69, s69, s53
    s_and_b32 s52, s52, 3
    s_cmp_eq_u32 s75, 0
    s_cselect_b32 s53, 24, 0
    s_add_u32 s52, s52, s53
L_ord15_d:
    s_mov_b32 s64, s52
    s_mul_i32 s69, s69, 28
    s_add_u32 s52, s52, s69
    s_mul_i32 s62, s52, 16384
    s_add_u32 s62, s62, s46
    s_mul_i32 s63, s52, 458752
    s_add_u32 s63, s63, s47
    buffer_load_dwordx4 v22, s[28:31], s49 offen offset:2048  lds
    s_add_u32 s55, s55, 16384
    s_add_u32 s56, s56, 16384
    s_cmp_eq_u32 s55, s57
    s_cselect_b32 s55, s50, s55
    s_cselect_b32 s56, s51, s56
    buffer_load_dwordx4 v23, s[28:31], s49 offen offset:3072  lds
    s_mov_b32 m0, s70
    s_nop 0
    buffer_load_dwordx4 v16, s[24:27], s48 offen offset:0 sc1 lds
    buffer_load_dwordx4 v16, s[24:27], s48 offen offset:1024 sc1 lds
    buffer_load_dwordx4 v16, s[24:27], s48 offen offset:2048 sc1 lds
    buffer_load_dwordx4 v16, s[24:27], s48 offen offset:3072 sc1 lds
    s_add_u32 m0, s70, 98304
    s_add_u32 s48, s48, s68
    buffer_load_dwordx4 v16, s[24:27], s48 offen offset:0 sc1 lds
    buffer_load_dwordx4 v16, s[24:27], s48 offen offset:1024 sc1 lds
    buffer_load_dwordx4 v16, s[24:27], s48 offen offset:2048 sc1 lds
    buffer_load_dwordx4 v16, s[24:27], s48 offen offset:3072 sc1 lds
    s_cmp_lt_u32 s54, 24
    s_waitcnt vmcnt(12)
    s_barrier
    s_cbranch_scc1 L_quip_kernel_go
    s_and_b32 s52, s90, s91
    s_and_b32 s52, s52, 0xfffffff
    s_cmp_eq_u32 s52, 0xfffffff
    s_cbranch_scc1 L_quip_kernel_pall
    s_mov_b32 s71, 0
L_pollpall:
    buffer_load_dword v25, v26, s[32:35], 0 offen sc1
    s_add_u32 s71, s71, 1
    s_waitcnt vmcnt(0)
    v_cmp_ne_u32 vcc, s65, v25
    s_cbranch_vccz L_pollpall_ok
    s_sleep 1
    s_cmp_lt_u32 s71, 65536
    s_cbranch_scc1 L_pollpall
L_pollpall_ok:
L_quip_kernel_pall:
    s_getpc_b64 s[22:23]
L_quip_kernel_pc:
    s_mov_b32 s52, L_quip_kernela2_m2-L_quip_kernel_pc
    s_cmp_lt_u32 s59, 3
    s_cselect_b32 s52, s52, -12288
    s_lshl_b32 s53, s59, 12
    s_add_u32 s52, s52, s53
    v_lshl_add_u32 v5, v2, 6, s52
    global_load_dword v29, v5, s[22:23]
    s_add_u32 s55, s50, 0
    s_add_u32 s56, s51, 0
    s_mov_b32 s48, s62
    s_mov_b32 s49, s63
    s_mov_b32 s70, s55
    s_mov_b32 s71, s56
    s_mov_b32 m0, s71
    s_nop 0
    buffer_load_dwordx4 v20, s[28:31], s49 offen offset:0  lds
    buffer_load_dwordx4 v21, s[28:31], s49 offen offset:1024  lds
    s_add_u32 s54, s54, 1
    s_mov_b32 s52, s61
    s_mov_b32 s69, s74
    s_cmp_eq_u32 s54, 0
    s_cbranch_scc1 L_ord16_d
    s_cmp_ge_u32 s54, 24
    s_cbranch_scc1 L_ord16_m
L_ord16:
    s_sub_u32 s52, s60, 1
    s_and_b32 s53, s52, 3
    s_cmp_eq_u32 s53, s42
    s_cselect_b32 s53, 4, 0
    s_cmp_ge_u32 s52, s58
    s_cselect_b32 s53, 1, s53
    s_add_u32 s52, s52, s53
    s_cmp_eq_u32 s60, 0
    s_cselect_b32 s52, s42, s52
    s_mov_b32 s89, s53
    s_add_u32 s52, s52, s75

    s_add_u32 s60, s60, 1
    s_cmp_eq_u32 s52, s61
    s_cbranch_scc1 L_ord16
    s_branch L_ord16_d
L_ord16_m:
    s_sub_u32 s52, s54, 25
    s_and_b32 s53, s52, 3
    s_cmp_eq_u32 s53, s42
    s_cselect_b32 s53, 4, 0
    s_sub_u32 s60, s52, 4
    s_cmp_ge_i32 s60, s42
    s_cselect_b32 s53, 1, s53
    s_add_u32 s52, s52, s53
    s_cmp_eq_u32 s54, 24
    s_cselect_b32 s52, s42, s52
    s_lshr_b32 s53, s52, 2
    s_and_b32 s53, s53, 1
    s_xor_b32 s69, s69, s53
    s_and_b32 s52, s52, 3
    s_cmp_eq_u32 s75, 0
    s_cselect_b32 s53, 24, 0
    s_add_u32 s52, s52, s53
L_ord16_d:
    s_mov_b32 s64, s52
    s_mul_i32 s69, s69, 28
    s_add_u32 s52, s52, s69
    s_mul_i32 s62, s52, 16384
    s_add_u32 s62, s62, s46
    s_mul_i32 s63, s52, 458752
    s_add_u32 s63, s63, s47
    buffer_load_dwordx4 v22, s[28:31], s49 offen offset:2048  lds
    s_add_u32 s55, s55, 16384
    s_add_u32 s56, s56, 16384
    s_cmp_eq_u32 s55, s57
    s_cselect_b32 s55, s50, s55
    s_cselect_b32 s56, s51, s56
    buffer_load_dwordx4 v23, s[28:31], s49 offen offset:3072  lds
    s_mov_b32 m0, s70
    s_nop 0
    buffer_load_dwordx4 v16, s[24:27], s48 offen offset:0 sc1 lds
    buffer_load_dwordx4 v16, s[24:27], s48 offen offset:1024 sc1 lds
    buffer_load_dwordx4 v16, s[24:27], s48 offen offset:2048 sc1 lds
    buffer_load_dwordx4 v16, s[24:27], s48 offen offset:3072 sc1 lds
    s_waitcnt vmcnt(9)
    s_barrier
    s_add_u32 s55, s50, 16384
    s_add_u32 s56, s51, 16384
    s_mov_b32 s48, s62
    s_mov_b32 s49, s63
    s_mov_b32 s70, s55
    s_mov_b32 s71, s56
    s_mov_b32 m0, s71
    s_nop 0
    buffer_load_dwordx4 v20, s[28:31], s49 offen offset:0  lds
    buffer_load_dwordx4 v21, s[28:31], s49 offen offset:1024  lds
    s_add_u32 s54, s54, 1
    s_mov_b32 s52, s61
    s_mov_b32 s69, s74
    s_cmp_eq_u32 s54, 0
    s_cbranch_scc1 L_ord17_d
    s_cmp_ge_u32 s54, 24
    s_cbranch_scc1 L_ord17_m
L_ord17:
    s_sub_u32 s52, s60, 1
    s_and_b32 s53, s52, 3
    s_cmp_eq_u32 s53, s42
    s_cselect_b32 s53, 4, 0
    s_cmp_ge_u32 s52, s58
    s_cselect_b32 s53, 1, s53
    s_add_u32 s52, s52, s53
    s_cmp_eq_u32 s60, 0
    s_cselect_b32 s52, s42, s52
    s_mov_b32 s89, s53
    s_add_u32 s52, s52, s75

    s_add_u32 s60, s60, 1
    s_cmp_eq_u32 s52, s61
    s_cbranch_scc1 L_ord17
    s_branch L_ord17_d
L_ord17_m:
    s_sub_u32 s52, s54, 25
    s_and_b32 s53, s52, 3
    s_cmp_eq_u32 s53, s42
    s_cselect_b32 s53, 4, 0
    s_sub_u32 s60, s52, 4
    s_cmp_ge_i32 s60, s42
    s_cselect_b32 s53, 1, s53
    s_add_u32 s52, s52, s53
    s_cmp_eq_u32 s54, 24
    s_cselect_b32 s52, s42, s52
    s_lshr_b32 s53, s52, 2
    s_and_b32 s53, s53, 1
    s_xor_b32 s69, s69, s53
    s_and_b32 s52, s52, 3
    s_cmp_eq_u32 s75, 0
    s_cselect_b32 s53, 24, 0
    s_add_u32 s52, s52, s53
L_ord17_d:
    s_mov_b32 s64, s52
    s_mul_i32 s69, s69, 28
    s_add_u32 s52, s52, s69
    s_mul_i32 s62, s52, 16384
    s_add_u32 s62, s62, s46
    s_mul_i32 s63, s52, 458752
    s_add_u32 s63, s63, s47
    buffer_load_dwordx4 v22, s[28:31], s49 offen offset:2048  lds
    s_add_u32 s55, s55, 16384
    s_add_u32 s56, s56, 16384
    s_cmp_eq_u32 s55, s57
    s_cselect_b32 s55, s50, s55
    s_cselect_b32 s56, s51, s56
    buffer_load_dwordx4 v23, s[28:31], s49 offen offset:3072  lds
    s_mov_b32 m0, s70
    s_nop 0
    buffer_load_dwordx4 v16, s[24:27], s48 offen offset:0 sc1 lds
    buffer_load_dwordx4 v16, s[24:27], s48 offen offset:1024 sc1 lds
    buffer_load_dwordx4 v16, s[24:27], s48 offen offset:2048 sc1 lds
    buffer_load_dwordx4 v16, s[24:27], s48 offen offset:3072 sc1 lds
    s_waitcnt vmcnt(8)
    s_barrier
    s_add_u32 s55, s50, 32768
    s_add_u32 s56, s51, 32768
    s_mov_b32 s48, s62
    s_mov_b32 s49, s63
    s_mov_b32 s70, s55
    s_mov_b32 s71, s56
    s_mov_b32 m0, s71
    s_nop 0
    buffer_load_dwordx4 v20, s[28:31], s49 offen offset:0  lds
    buffer_load_dwordx4 v21, s[28:31], s49 offen offset:1024  lds
    s_add_u32 s54, s54, 1
    s_mov_b32 s52, s61
    s_mov_b32 s69, s74
    s_cmp_eq_u32 s54, 0
    s_cbranch_scc1 L_ord18_d
    s_cmp_ge_u32 s54, 24
    s_cbranch_scc1 L_ord18_m
L_ord18:
    s_sub_u32 s52, s60, 1
    s_and_b32 s53, s52, 3
    s_cmp_eq_u32 s53, s42
    s_cselect_b32 s53, 4, 0
    s_cmp_ge_u32 s52, s58
    s_cselect_b32 s53, 1, s53
    s_add_u32 s52, s52, s53
    s_cmp_eq_u32 s60, 0
    s_cselect_b32 s52, s42, s52
    s_mov_b32 s89, s53
    s_add_u32 s52, s52, s75

    s_add_u32 s60, s60, 1
    s_cmp_eq_u32 s52, s61
    s_cbranch_scc1 L_ord18
    s_branch L_ord18_d
L_ord18_m:
    s_sub_u32 s52, s54, 25
    s_and_b32 s53, s52, 3
    s_cmp_eq_u32 s53, s42
    s_cselect_b32 s53, 4, 0
    s_sub_u32 s60, s52, 4
    s_cmp_ge_i32 s60, s42
    s_cselect_b32 s53, 1, s53
    s_add_u32 s52, s52, s53
    s_cmp_eq_u32 s54, 24
    s_cselect_b32 s52, s42, s52
    s_lshr_b32 s53, s52, 2
    s_and_b32 s53, s53, 1
    s_xor_b32 s69, s69, s53
    s_and_b32 s52, s52, 3
    s_cmp_eq_u32 s75, 0
    s_cselect_b32 s53, 24, 0
    s_add_u32 s52, s52, s53
L_ord18_d:
    s_mov_b32 s64, s52
    s_mul_i32 s69, s69, 28
    s_add_u32 s52, s52, s69
    s_mul_i32 s62, s52, 16384
    s_add_u32 s62, s62, s46
    s_mul_i32 s63, s52, 458752
    s_add_u32 s63, s63, s47
    buffer_load_dwordx4 v22, s[28:31], s49 offen offset:2048  lds
    s_add_u32 s55, s55, 16384
    s_add_u32 s56, s56, 16384
    s_cmp_eq_u32 s55, s57
    s_cselect_b32 s55, s50, s55
    s_cselect_b32 s56, s51, s56
    buffer_load_dwordx4 v23, s[28:31], s49 offen offset:3072  lds
    s_mov_b32 m0, s70
    s_nop 0
    buffer_load_dwordx4 v16, s[24:27], s48 offen offset:0 sc1 lds
    buffer_load_dwordx4 v16, s[24:27], s48 offen offset:1024 sc1 lds
    buffer_load_dwordx4 v16, s[24:27], s48 offen offset:2048 sc1 lds
    buffer_load_dwordx4 v16, s[24:27], s48 offen offset:3072 sc1 lds
    s_waitcnt vmcnt(8)
    s_barrier
    s_add_u32 s55, s50, 0
    s_add_u32 s56, s51, 0
    s_mov_b32 s48, s62
    s_mov_b32 s49, s63
    s_mov_b32 s70, s55
    s_mov_b32 s71, s56
    s_mov_b32 m0, s71
    s_nop 0
    buffer_load_dwordx4 v20, s[28:31], s49 offen offset:0  lds
    buffer_load_dwordx4 v21, s[28:31], s49 offen offset:1024  lds
    s_add_u32 s54, s54, 1
    s_mov_b32 s52, s61
    s_mov_b32 s69, s74
    s_cmp_eq_u32 s54, 0
    s_cbranch_scc1 L_ord19_d
    s_cmp_ge_u32 s54, 24
    s_cbranch_scc1 L_ord19_m
L_ord19:
    s_sub_u32 s52, s60, 1
    s_and_b32 s53, s52, 3
    s_cmp_eq_u32 s53, s42
    s_cselect_b32 s53, 4, 0
    s_cmp_ge_u32 s52, s58
    s_cselect_b32 s53, 1, s53
    s_add_u32 s52, s52, s53
    s_cmp_eq_u32 s60, 0
    s_cselect_b32 s52, s42, s52
    s_mov_b32 s89, s53
    s_add_u32 s52, s52, s75

    s_add_u32 s60, s60, 1
    s_cmp_eq_u32 s52, s61
    s_cbranch_scc1 L_ord19
    s_branch L_ord19_d
L_ord19_m:
    s_sub_u32 s52, s54, 25
    s_and_b32 s53, s52, 3
    s_cmp_eq_u32 s53, s42
    s_cselect_b32 s53, 4, 0
    s_sub_u32 s60, s52, 4
    s_cmp_ge_i32 s60, s42
    s_cselect_b32 s53, 1, s53
    s_add_u32 s52, s52, s53
    s_cmp_eq_u32 s54, 24
    s_cselect_b32 s52, s42, s52
    s_lshr_b32 s53, s52, 2
    s_and_b32 s53, s53, 1
    s_xor_b32 s69, s69, s53
    s_and_b32 s52, s52, 3
    s_cmp_eq_u32 s75, 0
    s_cselect_b32 s53, 24, 0
    s_add_u32 s52, s52, s53
L_ord19_d:
    s_mov_b32 s64, s52
    s_mul_i32 s69, s69, 28
    s_add_u32 s52, s52, s69
    s_mul_i32 s62, s52, 16384
    s_add_u32 s62, s62, s46
    s_mul_i32 s63, s52, 458752
    s_add_u32 s63, s63, s47
    buffer_load_dwordx4 v22, s[28:31], s49 offen offset:2048  lds
    s_add_u32 s55, s55, 16384
    s_add_u32 s56, s56, 16384
    s_cmp_eq_u32 s55, s57
    s_cselect_b32 s55, s50, s55
    s_cselect_b32 s56, s51, s56
    buffer_load_dwordx4 v23, s[28:31], s49 offen offset:3072  lds
    s_mov_b32 m0, s70
    s_nop 0
    buffer_load_dwordx4 v16, s[24:27], s48 offen offset:0 sc1 lds
    buffer_load_dwordx4 v16, s[24:27], s48 offen offset:1024 sc1 lds
    buffer_load_dwordx4 v16, s[24:27], s48 offen offset:2048 sc1 lds
    buffer_load_dwordx4 v16, s[24:27], s48 offen offset:3072 sc1 lds
    s_waitcnt vmcnt(8)
    s_barrier
    s_add_u32 s55, s50, 16384
    s_add_u32 s56, s51, 16384
    s_mov_b32 s48, s62
    s_mov_b32 s49, s63
    s_mov_b32 s70, s55
    s_mov_b32 s71, s56
    s_mov_b32 m0, s71
    s_nop 0
    buffer_load_dwordx4 v20, s[28:31], s49 offen offset:0  lds
    buffer_load_dwordx4 v21, s[28:31], s49 offen offset:1024  lds
    s_add_u32 s54, s54, 1
    s_mov_b32 s52, s61
    s_mov_b32 s69, s74
    s_cmp_eq_u32 s54, 0
    s_cbranch_scc1 L_ord20_d
    s_cmp_ge_u32 s54, 24
    s_cbranch_scc1 L_ord20_m
L_ord20:
    s_sub_u32 s52, s60, 1
    s_and_b32 s53, s52, 3
    s_cmp_eq_u32 s53, s42
    s_cselect_b32 s53, 4, 0
    s_cmp_ge_u32 s52, s58
    s_cselect_b32 s53, 1, s53
    s_add_u32 s52, s52, s53
    s_cmp_eq_u32 s60, 0
    s_cselect_b32 s52, s42, s52
    s_mov_b32 s89, s53
    s_add_u32 s52, s52, s75

    s_add_u32 s60, s60, 1
    s_cmp_eq_u32 s52, s61
    s_cbranch_scc1 L_ord20
    s_branch L_ord20_d
L_ord20_m:
    s_sub_u32 s52, s54, 25
    s_and_b32 s53, s52, 3
    s_cmp_eq_u32 s53, s42
    s_cselect_b32 s53, 4, 0
    s_sub_u32 s60, s52, 4
    s_cmp_ge_i32 s60, s42
    s_cselect_b32 s53, 1, s53
    s_add_u32 s52, s52, s53
    s_cmp_eq_u32 s54, 24
    s_cselect_b32 s52, s42, s52
    s_lshr_b32 s53, s52, 2
    s_and_b32 s53, s53, 1
    s_xor_b32 s69, s69, s53
    s_and_b32 s52, s52, 3
    s_cmp_eq_u32 s75, 0
    s_cselect_b32 s53, 24, 0
    s_add_u32 s52, s52, s53
L_ord20_d:
    s_mov_b32 s64, s52
    s_mul_i32 s69, s69, 28
    s_add_u32 s52, s52, s69
    s_mul_i32 s62, s52, 16384
    s_add_u32 s62, s62, s46
    s_mul_i32 s63, s52, 458752
    s_add_u32 s63, s63, s47
    buffer_load_dwordx4 v22, s[28:31], s49 offen offset:2048  lds
    s_add_u32 s55, s55, 16384
    s_add_u32 s56, s56, 16384
    s_cmp_eq_u32 s55, s57
    s_cselect_b32 s55, s50, s55
    s_cselect_b32 s56, s51, s56
    buffer_load_dwordx4 v23, s[28:31], s49 offen offset:3072  lds
    s_mov_b32 m0, s70
    s_nop 0
    buffer_load_dwordx4 v16, s[24:27], s48 offen offset:0 sc1 lds
    buffer_load_dwordx4 v16, s[24:27], s48 offen offset:1024 sc1 lds
    buffer_load_dwordx4 v16, s[24:27], s48 offen offset:2048 sc1 lds
    buffer_load_dwordx4 v16, s[24:27], s48 offen offset:3072 sc1 lds
    s_waitcnt vmcnt(8)
    s_barrier
    s_add_u32 s55, s50, 32768
    s_add_u32 s56, s51, 32768
    s_mov_b32 s48, s62
    s_mov_b32 s49, s63
    s_mov_b32 s70, s55
    s_mov_b32 s71, s56
    s_mov_b32 m0, s71
    s_nop 0
    buffer_load_dwordx4 v20, s[28:31], s49 offen offset:0  lds
    buffer_load_dwordx4 v21, s[28:31], s49 offen offset:1024  lds
    s_add_u32 s54, s54, 1
    s_mov_b32 s52, s61
    s_mov_b32 s69, s74
    s_cmp_eq_u32 s54, 0
    s_cbranch_scc1 L_ord21_d
    s_cmp_ge_u32 s54, 24
    s_cbranch_scc1 L_ord21_m
L_ord21:
    s_sub_u32 s52, s60, 1
    s_and_b32 s53, s52, 3
    s_cmp_eq_u32 s53, s42
    s_cselect_b32 s53, 4, 0
    s_cmp_ge_u32 s52, s58
    s_cselect_b32 s53, 1, s53
    s_add_u32 s52, s52, s53
    s_cmp_eq_u32 s60, 0
    s_cselect_b32 s52, s42, s52
    s_mov_b32 s89, s53
    s_add_u32 s52, s52, s75

    s_add_u32 s60, s60, 1
    s_cmp_eq_u32 s52, s61
    s_cbranch_scc1 L_ord21
    s_branch L_ord21_d
L_ord21_m:
    s_sub_u32 s52, s54, 25
    s_and_b32 s53, s52, 3
    s_cmp_eq_u32 s53, s42
    s_cselect_b32 s53, 4, 0
    s_sub_u32 s60, s52, 4
    s_cmp_ge_i32 s60, s42
    s_cselect_b32 s53, 1, s53
    s_add_u32 s52, s52, s53
    s_cmp_eq_u32 s54, 24
    s_cselect_b32 s52, s42, s52
    s_lshr_b32 s53, s52, 2
    s_and_b32 s53, s53, 1
    s_xor_b32 s69, s69, s53
    s_and_b32 s52, s52, 3
    s_cmp_eq_u32 s75, 0
    s_cselect_b32 s53, 24, 0
    s_add_u32 s52, s52, s53
L_ord21_d:
    s_mov_b32 s64, s52
    s_mul_i32 s69, s69, 28
    s_add_u32 s52, s52, s69
    s_mul_i32 s62, s52, 16384
    s_add_u32 s62, s62, s46
    s_mul_i32 s63, s52, 458752
    s_add_u32 s63, s63, s47
    buffer_load_dwordx4 v22, s[28:31], s49 offen offset:2048  lds
    s_add_u32 s55, s55, 16384
    s_add_u32 s56, s56, 16384
    s_cmp_eq_u32 s55, s57
    s_cselect_b32 s55, s50, s55
    s_cselect_b32 s56, s51, s56
    buffer_load_dwordx4 v23, s[28:31], s49 offen offset:3072  lds
    s_mov_b32 m0, s70
    s_nop 0
    buffer_load_dwordx4 v16, s[24:27], s48 offen offset:0 sc1 lds
    buffer_load_dwordx4 v16, s[24:27], s48 offen offset:1024 sc1 lds
    buffer_load_dwordx4 v16, s[24:27], s48 offen offset:2048 sc1 lds
    buffer_load_dwordx4 v16, s[24:27], s48 offen offset:3072 sc1 lds
    s_waitcnt vmcnt(8)
    s_barrier
    s_add_u32 s55, s50, 0
    s_add_u32 s56, s51, 0
    s_mov_b32 s48, s62
    s_mov_b32 s49, s63
    s_mov_b32 s70, s55
    s_mov_b32 s71, s56
    s_mov_b32 m0, s71
    s_nop 0
    buffer_load_dwordx4 v20, s[28:31], s49 offen offset:0  lds
    buffer_load_dwordx4 v21, s[28:31], s49 offen offset:1024  lds
    s_add_u32 s54, s54, 1
    s_mov_b32 s52, s61
    s_mov_b32 s69, s74
    s_cmp_eq_u32 s54, 0
    s_cbranch_scc1 L_ord22_d
    s_cmp_ge_u32 s54, 24
    s_cbranch_scc1 L_ord22_m
L_ord22:
    s_sub_u32 s52, s60, 1
    s_and_b32 s53, s52, 3
    s_cmp_eq_u32 s53, s42
    s_cselect_b32 s53, 4, 0
    s_cmp_ge_u32 s52, s58
    s_cselect_b32 s53, 1, s53
    s_add_u32 s52, s52, s53
    s_cmp_eq_u32 s60, 0
    s_cselect_b32 s52, s42, s52
    s_mov_b32 s89, s53
    s_add_u32 s52, s52, s75

    s_add_u32 s60, s60, 1
    s_cmp_eq_u32 s52, s61
    s_cbranch_scc1 L_ord22
    s_branch L_ord22_d
L_ord22_m:
    s_sub_u32 s52, s54, 25
    s_and_b32 s53, s52, 3
    s_cmp_eq_u32 s53, s42
    s_cselect_b32 s53, 4, 0
    s_sub_u32 s60, s52, 4
    s_cmp_ge_i32 s60, s42
    s_cselect_b32 s53, 1, s53
    s_add_u32 s52, s52, s53
    s_cmp_eq_u32 s54, 24
    s_cselect_b32 s52, s42, s52
    s_lshr_b32 s53, s52, 2
    s_and_b32 s53, s53, 1
    s_xor_b32 s69, s69, s53
    s_and_b32 s52, s52, 3
    s_cmp_eq_u32 s75, 0
    s_cselect_b32 s53, 24, 0
    s_add_u32 s52, s52, s53
L_ord22_d:
    s_mov_b32 s64, s52
    s_mul_i32 s69, s69, 28
    s_add_u32 s52, s52, s69
    s_mul_i32 s62, s52, 16384
    s_add_u32 s62, s62, s46
    s_mul_i32 s63, s52, 458752
    s_add_u32 s63, s63, s47
    buffer_load_dwordx4 v22, s[28:31], s49 offen offset:2048  lds
    s_add_u32 s55, s55, 16384
    s_add_u32 s56, s56, 16384
    s_cmp_eq_u32 s55, s57
    s_cselect_b32 s55, s50, s55
    s_cselect_b32 s56, s51, s56
    buffer_load_dwordx4 v23, s[28:31], s49 offen offset:3072  lds
    s_mov_b32 m0, s70
    s_nop 0
    buffer_load_dwordx4 v16, s[24:27], s48 offen offset:0 sc1 lds
    buffer_load_dwordx4 v16, s[24:27], s48 offen offset:1024 sc1 lds
    buffer_load_dwordx4 v16, s[24:27], s48 offen offset:2048 sc1 lds
    buffer_load_dwordx4 v16, s[24:27], s48 offen offset:3072 sc1 lds
    s_waitcnt vmcnt(8)
    s_barrier
    buffer_load_dword v25, v27, s[32:35], 0 offen sc1
    s_add_u32 s55, s50, 16384
    s_add_u32 s56, s51, 16384
    s_mov_b32 s48, s62
    s_mov_b32 s49, s63
    s_mov_b32 s70, s55
    s_mov_b32 s71, s56
    s_mov_b32 m0, s71
    s_nop 0
    buffer_load_dwordx4 v20, s[28:31], s49 offen offset:0  lds
    buffer_load_dwordx4 v21, s[28:31], s49 offen offset:1024  lds
    s_add_u32 s54, s54, 1
    s_mov_b32 s52, s61
    s_mov_b32 s69, s74
    s_cmp_eq_u32 s54, 0
    s_cbranch_scc1 L_ord23_d
    s_cmp_ge_u32 s54, 24
    s_cbranch_scc1 L_ord23_m
L_ord23:
    s_sub_u32 s52, s60, 1
    s_and_b32 s53, s52, 3
    s_cmp_eq_u32 s53, s42
    s_cselect_b32 s53, 4, 0
    s_cmp_ge_u32 s52, s58
    s_cselect_b32 s53, 1, s53
    s_add_u32 s52, s52, s53
    s_cmp_eq_u32 s60, 0
    s_cselect_b32 s52, s42, s52
    s_mov_b32 s89, s53
    s_add_u32 s52, s52, s75

    s_add_u32 s60, s60, 1
    s_cmp_eq_u32 s52, s61
    s_cbranch_scc1 L_ord23
    s_branch L_ord23_d
L_ord23_m:
    s_sub_u32 s52, s54, 25
    s_and_b32 s53, s52, 3
    s_cmp_eq_u32 s53, s42
    s_cselect_b32 s53, 4, 0
    s_sub_u32 s60, s52, 4
    s_cmp_ge_i32 s60, s42
    s_cselect_b32 s53, 1, s53
    s_add_u32 s52, s52, s53
    s_cmp_eq_u32 s54, 24
    s_cselect_b32 s52, s42, s52
    s_lshr_b32 s53, s52, 2
    s_and_b32 s53, s53, 1
    s_xor_b32 s69, s69, s53
    s_and_b32 s52, s52, 3
    s_cmp_eq_u32 s75, 0
    s_cselect_b32 s53, 24, 0
    s_add_u32 s52, s52, s53
L_ord23_d:
    s_mov_b32 s64, s52
    s_mul_i32 s69, s69, 28
    s_add_u32 s52, s52, s69
    s_mul_i32 s62, s52, 16384
    s_add_u32 s62, s62, s46
    s_mul_i32 s63, s52, 458752
    s_add_u32 s63, s63, s47
    buffer_load_dwordx4 v22, s[28:31], s49 offen offset:2048  lds
    s_add_u32 s55, s55, 16384
    s_add_u32 s56, s56, 16384
    s_cmp_eq_u32 s55, s57
    s_cselect_b32 s55, s50, s55
    s_cselect_b32 s56, s51, s56
    buffer_load_dwordx4 v23, s[28:31], s49 offen offset:3072  lds
    s_mov_b32 m0, s70
    s_nop 0
    buffer_load_dwordx4 v16, s[24:27], s48 offen offset:0 sc1 lds
    buffer_load_dwordx4 v16, s[24:27], s48 offen offset:1024 sc1 lds
    buffer_load_dwordx4 v16, s[24:27], s48 offen offset:2048 sc1 lds
    buffer_load_dwordx4 v16, s[24:27], s48 offen offset:3072 sc1 lds
    s_waitcnt vmcnt(8)
    v_cmp_eq_u32 vcc, s65, v25
    s_mov_b64 s[92:93], vcc
    s_mov_b32 s52, 983040
    s_mov_b32 s53, 65536
    s_andn2_b64 s[70:71], s[52:53], s[92:93]
    s_cbranch_scc0 L_nd24_ok
    s_mov_b32 s69, 0
L_nd24:
    buffer_load_dword v25, v27, s[32:35], 0 offen sc1
    s_add_u32 s69, s69, 1
    s_waitcnt vmcnt(0)
    v_cmp_eq_u32 vcc, s65, v25
    s_mov_b64 s[92:93], vcc
    s_andn2_b64 s[70:71], s[52:53], vcc
    s_cbranch_scc0 L_nd24_ok
    s_sleep 1
    s_cmp_lt_u32 s69, 65536
    s_cbranch_scc1 L_nd24
L_nd24_ok:
    s_barrier
    s_mul_i32 s52, s40, 589824
    s_lshl_b32 s53, s59, 13
    s_add_u32 s52, s52, s53
    s_add_u32 s52, s52, 8388608
    s_add_u32 m0, s53, 98304
    s_nop 0
    buffer_load_dwordx4 v16, s[32:35], s52 offen offset:0 sc1 lds
    buffer_load_dwordx4 v16, s[32:35], s52 offen offset:1024 sc1 lds
    buffer_load_dwordx4 v16, s[32:35], s52 offen offset:2048 sc1 lds
    buffer_load_dwordx4 v16, s[32:35], s52 offen offset:3072 sc1 lds
    s_add_u32 m0, m0, 4096
    s_add_u32 s52, s52, 4096
    buffer_load_dwordx4 v16, s[32:35], s52 offen offset:0 sc1 lds
    buffer_load_dwordx4 v16, s[32:35], s52 offen offset:1024 sc1 lds
    buffer_load_dwordx4 v16, s[32:35], s52 offen offset:2048 sc1 lds
    buffer_load_dwordx4 v16, s[32:35], s52 offen offset:3072 sc1 lds
    s_waitcnt vmcnt(8)
    s_barrier
    s_mul_i32 s52, s40, 589824
    s_lshl_b32 s53, s59, 13
    s_add_u32 s52, s52, s53
    s_add_u32 s52, s52, 8421376
    s_add_u32 m0, s53, 131072
    s_nop 0
    buffer_load_dwordx4 v16, s[32:35], s52 offen offset:0 sc1 lds
    buffer_load_dwordx4 v16, s[32:35], s52 offen offset:1024 sc1 lds
    buffer_load_dwordx4 v16, s[32:35], s52 offen offset:2048 sc1 lds
    buffer_load_dwordx4 v16, s[32:35], s52 offen offset:3072 sc1 lds
    s_add_u32 m0, m0, 4096
    s_add_u32 s52, s52, 4096
    buffer_load_dwordx4 v16, s[32:35], s52 offen offset:0 sc1 lds
    buffer_load_dwordx4 v16, s[32:35], s52 offen offset:1024 sc1 lds
    buffer_load_dwordx4 v16, s[32:35], s52 offen offset:2048 sc1 lds
    buffer_load_dwordx4 v16, s[32:35], s52 offen offset:3072 sc1 lds
    s_mov_b32 s61, s40
    s_mov_b32 s52, s40
    s_mov_b32 s40, s41
    s_mov_b32 s41, s52
    s_mov_b32 s24, s20
    s_mov_b32 s25, s21
    s_mov_b32 s26, 268435456
    s_mov_b32 s27, 0x20000
    s_mov_b32 s28, s20
    s_mov_b32 s29, s21
    s_mov_b32 s30, 268435456
    s_mov_b32 s31, 0x20000
    v_lshlrev_b32 v16, 4, v2
    s_mul_i32 s46, s40, 262144
    s_mul_i32 s52, s59, 4096
    s_add_u32 s52, s52, 12582912
    s_add_u32 s46, s46, s52
    v_lshlrev_b32 v20, 4, v2
    s_mul_i32 s47, s41, 524288
    s_mul_i32 s52, s59, 8192
    s_add_u32 s52, s52, 8388608
    s_add_u32 s47, s47, s52
    s_mul_i32 s50, s59, 4096
    s_add_u32 s50, s50, 0
    s_mul_i32 s51, s59, 8192
    s_add_u32 s51, s51, 65536
    s_add_u32 s57, s50, 49152
    s_add_u32 s58, s42, 12
    s_mov_b32 s54, 0
    s_mov_b32 s60, 0
    s_add_u32 s55, s50, 16384
    s_add_u32 s56, s51, 32768
    s_lshl_b32 s52, s61, 1
    s_add_u32 s52, s52, s54
    s_and_b32 s52, s52, 15
    s_mul_i32 s62, s52, 16384
    s_add_u32 s62, s62, s46
    s_mul_i32 s63, s52, 32768
    s_add_u32 s63, s63, s47
    s_mov_b32 s54, 2
    s_mov_b32 s55, s50
    s_mov_b32 s56, s51
    s_lshl_b32 s52, s61, 1
    s_add_u32 s52, s52, s54
    s_and_b32 s52, s52, 15
    s_mul_i32 s62, s52, 16384
    s_add_u32 s62, s62, s46
    s_mul_i32 s63, s52, 32768
    s_add_u32 s63, s63, s47
    s_barrier
    s_waitcnt vmcnt(8)
    s_mov_b32 s94, s54
    s_mov_b32 s95, s55
    s_mov_b32 s96, s56
    s_mov_b32 s97, s62
    s_mov_b32 s98, s63
    s_lshr_b32 s52, s54, 1
    s_lshl_b32 s53, s52, 2
    s_lshl_b64 s[68:69], s[72:73], s53
    s_andn2_b64 s[52:53], s[68:69], s[92:93]
    s_cbranch_scc0 L_ens25_ok
    s_mov_b32 s71, 0
L_ens25:
    buffer_load_dword v25, v27, s[32:35], 0 offen sc1
    s_add_u32 s71, s71, 1
    s_waitcnt vmcnt(0)
    v_cmp_eq_u32 vcc, s65, v25
    s_mov_b64 s[92:93], vcc
    s_andn2_b64 s[52:53], s[68:69], vcc
    s_cbranch_scc0 L_ens25_ok
    s_sleep 1
    s_cmp_lt_u32 s71, 65536
    s_cbranch_scc1 L_ens25
L_ens25_ok:
    s_barrier
    s_mov_b32 m0, s56
    s_mov_b32 s48, s62
    s_mov_b32 s49, s63
    buffer_load_dwordx4 v20, s[28:31], s49 offen offset:0 sc1 lds
    buffer_load_dwordx4 v20, s[28:31], s49 offen offset:1024 sc1 lds
    s_add_u32 s54, s54, 1
    s_lshl_b32 s52, s61, 1
    s_add_u32 s52, s52, s54
    s_and_b32 s52, s52, 15
    s_mul_i32 s62, s52, 16384
    s_add_u32 s62, s62, s46
    s_mul_i32 s63, s52, 32768
    s_add_u32 s63, s63, s47
    buffer_load_dwordx4 v20, s[28:31], s49 offen offset:2048 sc1 lds
    s_add_u32 s55, s55, 16384
    s_add_u32 s56, s56, 32768
    s_cmp_eq_u32 s55, s57
    s_cselect_b32 s55, s50, s55
    s_cselect_b32 s56, s51, s56
    s_cmp_lt_u32 s54, 16
    s_cselect_b32 s64, 1, 0
    buffer_load_dwordx4 v20, s[28:31], s49 offen offset:3072 sc1 lds
    s_add_u32 m0, m0, 4096
    s_add_u32 s49, s49, 4096
    buffer_load_dwordx4 v20, s[28:31], s49 offen offset:0 sc1 lds
    buffer_load_dwordx4 v20, s[28:31], s49 offen offset:1024 sc1 lds
    buffer_load_dwordx4 v20, s[28:31], s49 offen offset:2048 sc1 lds
    buffer_load_dwordx4 v20, s[28:31], s49 offen offset:3072 sc1 lds
    s_barrier
    s_waitcnt vmcnt(8)
    s_barrier
    buffer_load_dword v25, v27, s[32:35], 0 offen sc1
    s_mov_b32 m0, s56
    s_mov_b32 s48, s62
    s_mov_b32 s49, s63
    buffer_load_dwordx4 v20, s[28:31], s49 offen offset:0 sc1 lds
    buffer_load_dwordx4 v20, s[28:31], s49 offen offset:1024 sc1 lds
    s_add_u32 s54, s54, 1
    s_lshl_b32 s52, s61, 1
    s_add_u32 s52, s52, s54
    s_and_b32 s52, s52, 15
    s_mul_i32 s62, s52, 16384
    s_add_u32 s62, s62, s46
    s_mul_i32 s63, s52, 32768
    s_add_u32 s63, s63, s47
    buffer_load_dwordx4 v20, s[28:31], s49 offen offset:2048 sc1 lds
    s_add_u32 s55, s55, 16384
    s_add_u32 s56, s56, 32768
    s_cmp_eq_u32 s55, s57
    s_cselect_b32 s55, s50, s55
    s_cselect_b32 s56, s51, s56
    s_cmp_lt_u32 s54, 16
    s_cselect_b32 s64, 1, 0
    buffer_load_dwordx4 v20, s[28:31], s49 offen offset:3072 sc1 lds
    s_add_u32 m0, m0, 4096
    s_add_u32 s49, s49, 4096
    buffer_load_dwordx4 v20, s[28:31], s49 offen offset:0 sc1 lds
    buffer_load_dwordx4 v20, s[28:31], s49 offen offset:1024 sc1 lds
    buffer_load_dwordx4 v20, s[28:31], s49 offen offset:2048 sc1 lds
    buffer_load_dwordx4 v20, s[28:31], s49 offen offset:3072 sc1 lds
    s_mov_b32 s54, s94
    s_mov_b32 s55, s95
    s_mov_b32 s56, s96
    s_mov_b32 s62, s97
    s_mov_b32 s63, s98
    s_waitcnt vmcnt(8)
    v_cmp_eq_u32 vcc, s65, v25
    s_mov_b64 s[92:93], vcc
    s_lshr_b32 s52, s54, 1
    s_mov_b64 s[68:69], 0
    s_add_u32 s52, s52, s61
    s_and_b32 s52, s52, 7
    s_bitset1_b64 s[68:69], s52
    s_andn2_b64 s[52:53], s[68:69], s[92:93]
    s_cbranch_scc0 L_ens26_ok
    s_mov_b32 s71, 0
L_ens26:
    buffer_load_dword v25, v27, s[32:35], 0 offen sc1
    s_add_u32 s71, s71, 1
    s_waitcnt vmcnt(0)
    v_cmp_eq_u32 vcc, s65, v25
    s_mov_b64 s[92:93], vcc
    s_andn2_b64 s[52:53], s[68:69], vcc
    s_cbranch_scc0 L_ens26_ok
    s_sleep 1
    s_cmp_lt_u32 s71, 65536
    s_cbranch_scc1 L_ens26
L_ens26_ok:
    s_mov_b32 m0, s55
    s_mov_b32 s48, s62
    s_mov_b32 s49, s63
    buffer_load_dwordx4 v16, s[24:27], s48 offen offset:0 sc1 lds
    buffer_load_dwordx4 v16, s[24:27], s48 offen offset:1024 sc1 lds
    s_add_u32 s54, s54, 1
    s_lshl_b32 s52, s61, 1
    s_add_u32 s52, s52, s54
    s_and_b32 s52, s52, 15
    s_mul_i32 s62, s52, 16384
    s_add_u32 s62, s62, s46
    s_mul_i32 s63, s52, 32768
    s_add_u32 s63, s63, s47
    buffer_load_dwordx4 v16, s[24:27], s48 offen offset:2048 sc1 lds
    s_add_u32 s55, s55, 16384
    s_add_u32 s56, s56, 32768
    s_cmp_eq_u32 s55, s57
    s_cselect_b32 s55, s50, s55
    s_cselect_b32 s56, s51, s56
    s_cmp_lt_u32 s54, 16
    s_cselect_b32 s64, 1, 0
    buffer_load_dwordx4 v16, s[24:27], s48 offen offset:3072 sc1 lds
    s_mov_b32 m0, s55
    s_mov_b32 s48, s62
    s_mov_b32 s49, s63
    buffer_load_dwordx4 v16, s[24:27], s48 offen offset:0 sc1 lds
    buffer_load_dwordx4 v16, s[24:27], s48 offen offset:1024 sc1 lds
    s_add_u32 s54, s54, 1
    s_lshl_b32 s52, s61, 1
    s_add_u32 s52, s52, s54
    s_and_b32 s52, s52, 15
    s_mul_i32 s62, s52, 16384
    s_add_u32 s62, s62, s46
    s_mul_i32 s63, s52, 32768
    s_add_u32 s63, s63, s47
    buffer_load_dwordx4 v16, s[24:27], s48 offen offset:2048 sc1 lds
    s_add_u32 s55, s55, 16384
    s_add_u32 s56, s56, 32768
    s_cmp_eq_u32 s55, s57
    s_cselect_b32 s55, s50, s55
    s_cselect_b32 s56, s51, s56
    s_cmp_lt_u32 s54, 16
    s_cselect_b32 s64, 1, 0
    buffer_load_dwordx4 v16, s[24:27], s48 offen offset:3072 sc1 lds
    s_waitcnt vmcnt(4)
L_quip_kernel_joinb:
    s_barrier
.p2align 6
L_quip_kernelb_go:
    s_lshr_b32 s52, s54, 1
    s_lshl_b32 s53, s52, 2
    s_lshl_b64 s[68:69], s[72:73], s53
    s_add_u32 s52, s52, s61
    s_and_b32 s52, s52, 7
    s_bitset1_b64 s[68:69], s52
    s_andn2_b64 s[52:53], s[68:69], s[92:93]
    s_cbranch_scc0 L_ens27_ok
    s_mov_b32 s71, 0
L_ens27:
    buffer_load_dword v25, v27, s[32:35], 0 offen sc1
    s_add_u32 s71, s71, 1
    s_waitcnt vmcnt(0)
    v_cmp_eq_u32 vcc, s65, v25
    s_mov_b64 s[92:93], vcc
    s_andn2_b64 s[52:53], s[68:69], vcc
    s_cbranch_scc0 L_ens27_ok
    s_sleep 1
    s_cmp_lt_u32 s71, 65536
    s_cbranch_scc1 L_ens27
L_ens27_ok:
    s_mov_b32 m0, s55
    s_mov_b32 s48, s62
    s_mov_b32 s49, s63
    buffer_load_dwordx4 v16, s[24:27], s48 offen offset:0 sc1 lds
    buffer_load_dwordx4 v16, s[24:27], s48 offen offset:1024 sc1 lds
    s_add_u32 s54, s54, 1
    s_lshl_b32 s52, s61, 1
    s_add_u32 s52, s52, s54
    s_and_b32 s52, s52, 15
    s_mul_i32 s62, s52, 16384
    s_add_u32 s62, s62, s46
    s_mul_i32 s63, s52, 32768
    s_add_u32 s63, s63, s47
    buffer_load_dwordx4 v16, s[24:27], s48 offen offset:2048 sc1 lds
    buffer_load_dwordx4 v16, s[24:27], s48 offen offset:3072 sc1 lds
    s_mov_b32 m0, s56
    s_nop 0
    buffer_load_dwordx4 v20, s[28:31], s49 offen offset:0 sc1 lds
    s_add_u32 s55, s55, 16384
    s_add_u32 s56, s56, 32768
    s_cmp_eq_u32 s55, s57
    s_cselect_b32 s55, s50, s55
    s_cselect_b32 s56, s51, s56
    s_cmp_lt_u32 s54, 16
    s_cselect_b32 s64, 1, 0
    buffer_load_dwordx4 v20, s[28:31], s49 offen offset:1024 sc1 lds
    buffer_load_dwordx4 v20, s[28:31], s49 offen offset:2048 sc1 lds
    buffer_load_dwordx4 v20, s[28:31], s49 offen offset:3072 sc1 lds
    s_add_u32 m0, m0, 4096
    s_add_u32 s49, s49, 4096
    buffer_load_dwordx4 v20, s[28:31], s49 offen offset:0 sc1 lds
    buffer_load_dwordx4 v20, s[28:31], s49 offen offset:1024 sc1 lds
    buffer_load_dwordx4 v20, s[28:31], s49 offen offset:2048 sc1 lds
    buffer_load_dwordx4 v20, s[28:31], s49 offen offset:3072 sc1 lds
    s_cmp_eq_u32 s64, 1
    s_waitcnt vmcnt(12)
    s_barrier
    s_cbranch_scc1 L_quip_kernelb_go
    s_waitcnt vmcnt(0)
    s_barrier
    s_endpgm
L_quip_kernel_A2c:
    v_bfe_u32 v5, v3, 2, 1
    v_lshlrev_b32 v12, 10, v5
    v_lshrrev_b32 v5, 3, v3
    v_lshl_add_u32 v12, v5, 6, v12
    v_and_b32 v5, 3, v3
    v_lshl_add_u32 v12, v5, 4, v12
    v_lshl_add_u32 v12, v4, 8, v12

    s_lshl_b32 s52, s41, 5
    s_lshl_b32 s53, s40, 2
    s_add_u32 s52, s52, s53
    s_lshl_b32 s53, s44, 1
    s_add_u32 s52, s52, s53
    s_lshl_b32 s52, s52, 1
    s_add_u32 s52, s52, s45
    s_lshl_b32 s60, s52, 12
    s_add_u32 s60, s60, 12582912
    s_add_u32 s61, s60, 8192
    s_add_u32 s52, s44, 1
    s_lshl_b32 s52, s52, 14
    s_lshl_b32 s53, s45, 12
    s_add_u32 s52, s52, s53
    v_add_u32 v9, s52, v12
    s_lshl_b32 s70, s40, 9
    s_lshr_b32 s53, s66, 1
    s_mul_i32 s53, s53, 25
    s_add_u32 s53, s53, s73
    s_lshl_b32 s53, s53, 2
    s_add_u32 s70, s70, s53
    s_add_u32 s70, s70, 22020096
    s_waitcnt vmcnt(0) lgkmcnt(0)
    v_readfirstlane_b32 s65, v11
    s_cmp_lg_u32 s65, 0
    s_cbranch_scc1 L_quip_kernel_cn
    v_mov_b32 v10, 0
    s_mov_b32 s71, 0
L_noncec:
    global_load_dword v11, v10, s[18:19] sc1
    s_add_u32 s71, s71, 1
    s_waitcnt vmcnt(0)
    v_readfirstlane_b32 s65, v11
    s_cmp_gt_u32 s71, 65536
    s_cbranch_scc1 L_noncec_ok
    s_cmp_eq_u32 s65, 0
    s_cbranch_scc1 L_noncec
L_noncec_ok:
L_quip_kernel_cn:
    s_barrier
    s_cmp_eq_u32 s43, 0
    s_cbranch_scc0 L_pfp
    v_mov_b32 v10, 0
    v_mov_b32 v11, s65
    s_mov_b64 exec, 1
    buffer_store_dword v11, v10, s[32:35], s70 offen sc1
    s_mov_b64 exec, -1
L_pfp:
    s_lshl_b32 s70, s41, 7
    s_lshl_b32 s53, s40, 2
    s_add_u32 s70, s70, s53
    s_add_u32 s70, s70, 22085632
    s_lshl_b32 s52, s41, 3
    s_add_u32 s52, s52, s40
    s_lshl_b32 s64, s52, 7
    s_add_u32 s64, s64, 22216704
    s_mul_i32 s62, s52, 36864
    s_xor_b32 s52, s52, 4
    s_mul_i32 s63, s52, 36864
    s_mul_i32 s53, s43, 9216
    s_add_u32 s53, s53, 25165824
    s_add_u32 s62, s62, s53
    s_add_u32 s63, s63, s53
    v_lshlrev_b32 v13, 4, v2
    s_mul_i32 s52, s44, 8192
    s_add_u32 s52, s52, 0
    v_lshl_add_u32 v5, v3, 7, s52
    v_lshrrev_b32 v6, 1, v3
    v_xor_b32 v6, v6, v4
    v_lshl_add_u32 v16, v6, 4, v5
    v_xor_b32 v6, 4, v6
    v_lshl_add_u32 v17, v6, 4, v5
    v_lshrrev_b32 v5, 2, v3
    v_lshl_add_u32 v6, v4, 3, v5
    v_lshlrev_b32 v6, 8, v6
    v_and_b32 v7, 3, v2
    v_lshl_add_u32 v6, v7, 3, v6
    v_add_u32 v6, 49152, v6
    v_and_b32 v7, 1, v4
    v_lshl_or_b32 v5, v7, 2, v5
    s_mul_i32 s52, s45, 4
    s_add_u32 s53, s52, 0
    v_xor_b32 v7, s53, v5
    v_lshl_add_u32 v20, v7, 5, v6
    s_add_u32 s53, s52, 1
    v_xor_b32 v7, s53, v5
    v_lshl_add_u32 v21, v7, 5, v6
    s_add_u32 s53, s52, 2
    v_xor_b32 v7, s53, v5
    v_lshl_add_u32 v22, v7, 5, v6
    s_add_u32 s53, s52, 3
    v_xor_b32 v7, s53, v5
    v_lshl_add_u32 v23, v7, 5, v6
    v_add_u32 v18, 98304, v16
    v_add_u32 v19, 98304, v17
    v_and_b32 v5, 1, v2
    v_lshlrev_b32 v5, 4, v5
    v_mov_b32 v6, 0x3f80
    v_lshlrev_b32 v5, v5, v6
    v_lshrrev_b32 v6, 1, v3
    v_lshlrev_b32 v8, 1, v4
    v_cmp_eq_u32 vcc, v6, v8
    v_add_u32 v8, 1, v8
    s_nop 0
    v_cndmask_b32 v7, 0, v5, vcc
    v_cmp_eq_u32 vcc, v6, v8
    s_nop 1
    v_cndmask_b32 v8, 0, v5, vcc
    s_barrier
    ds_read_b128 v[24:27], v16 offset:0
    ds_read_b128 v[28:31], v16 offset:2048
    ds_read_b128 v[32:35], v16 offset:4096
    ds_read_b128 v[36:39], v16 offset:6144
    ds_read_b64_tr_b16 v[56:57], v20 offset:0
    ds_read_b64_tr_b16 v[58:59], v20 offset:1024
    ds_read_b64_tr_b16 v[60:61], v21 offset:0
    ds_read_b64_tr_b16 v[62:63], v21 offset:1024
    ds_read_b64_tr_b16 v[64:65], v22 offset:0
    ds_read_b64_tr_b16 v[66:67], v22 offset:1024
    ds_read_b64_tr_b16 v[68:69], v23 offset:0
    ds_read_b64_tr_b16 v[70:71], v23 offset:1024
    ds_read_b128 v[40:43], v18 offset:0
    ds_read_b128 v[44:47], v18 offset:2048
    ds_read_b128 v[48:51], v18 offset:4096
    ds_read_b128 v[52:55], v18 offset:6144
    s_waitcnt lgkmcnt(0)
    v_mfma_f32_16x16x32_bf16 v[120:123], v[24:27], v[56:59], 0
    ds_read_b128 v[72:75], v17 offset:0
    v_mfma_f32_16x16x32_bf16 v[136:139], v[28:31], v[56:59], 0
    ds_read_b128 v[76:79], v17 offset:2048
    v_mfma_f32_16x16x32_bf16 v[140:143], v[28:31], v[60:63], 0
    ds_read_b128 v[80:83], v17 offset:4096
    v_mfma_f32_16x16x32_bf16 v[124:127], v[24:27], v[60:63], 0
    ds_read_b128 v[84:87], v17 offset:6144
    v_mfma_f32_16x16x32_bf16 v[128:131], v[24:27], v[64:67], 0
    ds_read_b64_tr_b16 v[104:105], v20 offset:8192
    v_mfma_f32_16x16x32_bf16 v[144:147], v[28:31], v[64:67], 0
    ds_read_b64_tr_b16 v[106:107], v20 offset:9216
    v_mfma_f32_16x16x32_bf16 v[148:151], v[28:31], v[68:71], 0
    ds_read_b64_tr_b16 v[108:109], v21 offset:8192
    v_mfma_f32_16x16x32_bf16 v[132:135], v[24:27], v[68:71], 0
    ds_read_b64_tr_b16 v[110:111], v21 offset:9216
    v_mfma_f32_16x16x32_bf16 v[164:167], v[32:35], v[68:71], 0
    ds_read_b64_tr_b16 v[112:113], v22 offset:8192
    v_mfma_f32_16x16x32_bf16 v[180:183], v[36:39], v[68:71], 0
    ds_read_b64_tr_b16 v[114:115], v22 offset:9216
    v_mfma_f32_16x16x32_bf16 v[176:179], v[36:39], v[64:67], 0
    ds_read_b64_tr_b16 v[116:117], v23 offset:8192
    v_mfma_f32_16x16x32_bf16 v[160:163], v[32:35], v[64:67], 0
    ds_read_b64_tr_b16 v[118:119], v23 offset:9216
    v_mfma_f32_16x16x32_bf16 v[156:159], v[32:35], v[60:63], 0
    ds_read_b128 v[88:91], v19 offset:0
    v_mfma_f32_16x16x32_bf16 v[172:175], v[36:39], v[60:63], 0
    ds_read_b128 v[92:95], v19 offset:2048
    v_mfma_f32_16x16x32_bf16 v[168:171], v[36:39], v[56:59], 0
    ds_read_b128 v[96:99], v19 offset:4096
    v_mfma_f32_16x16x32_bf16 v[152:155], v[32:35], v[56:59], 0
    ds_read_b128 v[100:103], v19 offset:6144
    v_mfma_f32_16x16x32_bf16 v[184:187], v[40:43], v[56:59], 0
    s_mov_b32 s57, 1
    v_mfma_f32_16x16x32_bf16 v[200:203], v[44:47], v[56:59], 0
    v_mfma_f32_16x16x32_bf16 v[204:207], v[44:47], v[60:63], 0
    v_mfma_f32_16x16x32_bf16 v[188:191], v[40:43], v[60:63], 0
    v_mfma_f32_16x16x32_bf16 v[192:195], v[40:43], v[64:67], 0
    v_mfma_f32_16x16x32_bf16 v[208:211], v[44:47], v[64:67], 0
    v_mfma_f32_16x16x32_bf16 v[212:215], v[44:47], v[68:71], 0
    v_mfma_f32_16x16x32_bf16 v[196:199], v[40:43], v[68:71], 0
    v_mfma_f32_16x16x32_bf16 v[228:231], v[48:51], v[68:71], 0
    v_mfma_f32_16x16x32_bf16 v[244:247], v[52:55], v[68:71], 0
    v_mfma_f32_16x16x32_bf16 v[240:243], v[52:55], v[64:67], 0
    v_mfma_f32_16x16x32_bf16 v[224:227], v[48:51], v[64:67], 0
    v_mfma_f32_16x16x32_bf16 v[220:223], v[48:51], v[60:63], 0
    v_mfma_f32_16x16x32_bf16 v[236:239], v[52:55], v[60:63], 0
    v_mfma_f32_16x16x32_bf16 v[232:235], v[52:55], v[56:59], 0
    v_mfma_f32_16x16x32_bf16 v[216:219], v[48:51], v[56:59], 0
    s_waitcnt lgkmcnt(0)
    v_mfma_f32_16x16x32_bf16 v[120:123], v[72:75], v[104:107], v[120:123]
    v_mfma_f32_16x16x32_bf16 v[136:139], v[76:79], v[104:107], v[136:139]
    v_mfma_f32_16x16x32_bf16 v[140:143], v[76:79], v[108:111], v[140:143]
    v_mfma_f32_16x16x32_bf16 v[124:127], v[72:75], v[108:111], v[124:127]
    v_mfma_f32_16x16x32_bf16 v[128:131], v[72:75], v[112:115], v[128:131]
    v_mfma_f32_16x16x32_bf16 v[144:147], v[76:79], v[112:115], v[144:147]
    v_mfma_f32_16x16x32_bf16 v[148:151], v[76:79], v[116:119], v[148:151]
    v_mfma_f32_16x16x32_bf16 v[132:135], v[72:75], v[116:119], v[132:135]
    v_mfma_f32_16x16x32_bf16 v[164:167], v[80:83], v[116:119], v[164:167]
    v_mfma_f32_16x16x32_bf16 v[180:183], v[84:87], v[116:119], v[180:183]
    v_mfma_f32_16x16x32_bf16 v[176:179], v[84:87], v[112:115], v[176:179]
    v_mfma_f32_16x16x32_bf16 v[160:163], v[80:83], v[112:115], v[160:163]
    v_mfma_f32_16x16x32_bf16 v[156:159], v[80:83], v[108:111], v[156:159]
    v_mfma_f32_16x16x32_bf16 v[172:175], v[84:87], v[108:111], v[172:175]
    v_mfma_f32_16x16x32_bf16 v[168:171], v[84:87], v[104:107], v[168:171]
    v_mfma_f32_16x16x32_bf16 v[152:155], v[80:83], v[104:107], v[152:155]
    v_mfma_f32_16x16x32_bf16 v[184:187], v[88:91], v[104:107], v[184:187]
    v_mfma_f32_16x16x32_bf16 v[200:203], v[92:95], v[104:107], v[200:203]
    v_mfma_f32_16x16x32_bf16 v[204:207], v[92:95], v[108:111], v[204:207]
    v_mfma_f32_16x16x32_bf16 v[188:191], v[88:91], v[108:111], v[188:191]
    v_mfma_f32_16x16x32_bf16 v[192:195], v[88:91], v[112:115], v[192:195]
    v_mfma_f32_16x16x32_bf16 v[208:211], v[92:95], v[112:115], v[208:211]
    v_mfma_f32_16x16x32_bf16 v[212:215], v[92:95], v[116:119], v[212:215]
    v_mfma_f32_16x16x32_bf16 v[196:199], v[88:91], v[116:119], v[196:199]
    v_mfma_f32_16x16x32_bf16 v[228:231], v[96:99], v[116:119], v[228:231]
    v_mfma_f32_16x16x32_bf16 v[244:247], v[100:103], v[116:119], v[244:247]
    v_mfma_f32_16x16x32_bf16 v[240:243], v[100:103], v[112:115], v[240:243]
    v_mfma_f32_16x16x32_bf16 v[224:227], v[96:99], v[112:115], v[224:227]
    v_mfma_f32_16x16x32_bf16 v[220:223], v[96:99], v[108:111], v[220:223]
    v_mfma_f32_16x16x32_bf16 v[236:239], v[100:103], v[108:111], v[236:239]
    v_mfma_f32_16x16x32_bf16 v[232:235], v[100:103], v[104:107], v[232:235]
    v_mfma_f32_16x16x32_bf16 v[216:219], v[96:99], v[104:107], v[216:219]
    s_barrier
    ds_read_b128 v[24:27], v16 offset:16384
    ds_read_b128 v[28:31], v16 offset:18432
    ds_read_b128 v[32:35], v16 offset:20480
    ds_read_b128 v[36:39], v16 offset:22528
    ds_read_b64_tr_b16 v[56:57], v20 offset:16384
    ds_read_b64_tr_b16 v[58:59], v20 offset:17408
    ds_read_b64_tr_b16 v[60:61], v21 offset:16384
    ds_read_b64_tr_b16 v[62:63], v21 offset:17408
    ds_read_b64_tr_b16 v[64:65], v22 offset:16384
    ds_read_b64_tr_b16 v[66:67], v22 offset:17408
    ds_read_b64_tr_b16 v[68:69], v23 offset:16384
    ds_read_b64_tr_b16 v[70:71], v23 offset:17408
    ds_read_b128 v[40:43], v18 offset:16384
    ds_read_b128 v[44:47], v18 offset:18432
    ds_read_b128 v[48:51], v18 offset:20480
    ds_read_b128 v[52:55], v18 offset:22528
    s_branch L_quip_kernela2_c1
.p2align 6
L_quip_kernela2_c0:
    s_waitcnt lgkmcnt(0)
    v_mfma_f32_16x16x32_bf16 v[120:123], v[24:27], v[56:59], v[120:123]
    ds_read_b128 v[72:75], v17 offset:0
    v_mfma_f32_16x16x32_bf16 v[136:139], v[28:31], v[56:59], v[136:139]
    ds_read_b128 v[76:79], v17 offset:2048
    v_mfma_f32_16x16x32_bf16 v[140:143], v[28:31], v[60:63], v[140:143]
    ds_read_b128 v[80:83], v17 offset:4096
    v_mfma_f32_16x16x32_bf16 v[124:127], v[24:27], v[60:63], v[124:127]
    ds_read_b128 v[84:87], v17 offset:6144
    v_mfma_f32_16x16x32_bf16 v[128:131], v[24:27], v[64:67], v[128:131]
    ds_read_b64_tr_b16 v[104:105], v20 offset:8192
    v_mfma_f32_16x16x32_bf16 v[144:147], v[28:31], v[64:67], v[144:147]
    ds_read_b64_tr_b16 v[106:107], v20 offset:9216
    v_mfma_f32_16x16x32_bf16 v[148:151], v[28:31], v[68:71], v[148:151]
    ds_read_b64_tr_b16 v[108:109], v21 offset:8192
    v_mfma_f32_16x16x32_bf16 v[132:135], v[24:27], v[68:71], v[132:135]
    ds_read_b64_tr_b16 v[110:111], v21 offset:9216
    v_mfma_f32_16x16x32_bf16 v[164:167], v[32:35], v[68:71], v[164:167]
    ds_read_b64_tr_b16 v[112:113], v22 offset:8192
    v_mfma_f32_16x16x32_bf16 v[180:183], v[36:39], v[68:71], v[180:183]
    ds_read_b64_tr_b16 v[114:115], v22 offset:9216
    v_mfma_f32_16x16x32_bf16 v[176:179], v[36:39], v[64:67], v[176:179]
    ds_read_b64_tr_b16 v[116:117], v23 offset:8192
    v_mfma_f32_16x16x32_bf16 v[160:163], v[32:35], v[64:67], v[160:163]
    ds_read_b64_tr_b16 v[118:119], v23 offset:9216
    v_mfma_f32_16x16x32_bf16 v[156:159], v[32:35], v[60:63], v[156:159]
    ds_read_b128 v[88:91], v19 offset:0
    v_mfma_f32_16x16x32_bf16 v[172:175], v[36:39], v[60:63], v[172:175]
    ds_read_b128 v[92:95], v19 offset:2048
    v_mfma_f32_16x16x32_bf16 v[168:171], v[36:39], v[56:59], v[168:171]
    ds_read_b128 v[96:99], v19 offset:4096
    v_mfma_f32_16x16x32_bf16 v[152:155], v[32:35], v[56:59], v[152:155]
    ds_read_b128 v[100:103], v19 offset:6144
    v_mfma_f32_16x16x32_bf16 v[184:187], v[40:43], v[56:59], v[184:187]
    s_add_u32 s57, s57, 1
    s_cmp_lt_u32 s57, 24
    v_mfma_f32_16x16x32_bf16 v[200:203], v[44:47], v[56:59], v[200:203]
    v_mfma_f32_16x16x32_bf16 v[204:207], v[44:47], v[60:63], v[204:207]
    v_mfma_f32_16x16x32_bf16 v[188:191], v[40:43], v[60:63], v[188:191]
    v_mfma_f32_16x16x32_bf16 v[192:195], v[40:43], v[64:67], v[192:195]
    v_mfma_f32_16x16x32_bf16 v[208:211], v[44:47], v[64:67], v[208:211]
    v_mfma_f32_16x16x32_bf16 v[212:215], v[44:47], v[68:71], v[212:215]
    v_mfma_f32_16x16x32_bf16 v[196:199], v[40:43], v[68:71], v[196:199]
    v_mfma_f32_16x16x32_bf16 v[228:231], v[48:51], v[68:71], v[228:231]
    v_mfma_f32_16x16x32_bf16 v[244:247], v[52:55], v[68:71], v[244:247]
    v_mfma_f32_16x16x32_bf16 v[240:243], v[52:55], v[64:67], v[240:243]
    v_mfma_f32_16x16x32_bf16 v[224:227], v[48:51], v[64:67], v[224:227]
    v_mfma_f32_16x16x32_bf16 v[220:223], v[48:51], v[60:63], v[220:223]
    v_mfma_f32_16x16x32_bf16 v[236:239], v[52:55], v[60:63], v[236:239]
    v_mfma_f32_16x16x32_bf16 v[232:235], v[52:55], v[56:59], v[232:235]
    v_mfma_f32_16x16x32_bf16 v[216:219], v[48:51], v[56:59], v[216:219]
L_quip_kernela2_m0:
    s_waitcnt lgkmcnt(0)
    s_barrier
    v_mfma_f32_16x16x32_bf16 v[120:123], v[72:75], v[104:107], v[120:123]
    ds_read_b128 v[24:27], v16 offset:16384
    v_mfma_f32_16x16x32_bf16 v[136:139], v[76:79], v[104:107], v[136:139]
    ds_read_b128 v[28:31], v16 offset:18432
    v_mfma_f32_16x16x32_bf16 v[140:143], v[76:79], v[108:111], v[140:143]
    ds_read_b128 v[32:35], v16 offset:20480
    v_mfma_f32_16x16x32_bf16 v[124:127], v[72:75], v[108:111], v[124:127]
    ds_read_b128 v[36:39], v16 offset:22528
    v_mfma_f32_16x16x32_bf16 v[128:131], v[72:75], v[112:115], v[128:131]
    ds_read_b64_tr_b16 v[56:57], v20 offset:16384
    v_mfma_f32_16x16x32_bf16 v[144:147], v[76:79], v[112:115], v[144:147]
    ds_read_b64_tr_b16 v[58:59], v20 offset:17408
    v_mfma_f32_16x16x32_bf16 v[148:151], v[76:79], v[116:119], v[148:151]
    ds_read_b64_tr_b16 v[60:61], v21 offset:16384
    v_mfma_f32_16x16x32_bf16 v[132:135], v[72:75], v[116:119], v[132:135]
    ds_read_b64_tr_b16 v[62:63], v21 offset:17408
    v_mfma_f32_16x16x32_bf16 v[164:167], v[80:83], v[116:119], v[164:167]
    ds_read_b64_tr_b16 v[64:65], v22 offset:16384
    v_mfma_f32_16x16x32_bf16 v[180:183], v[84:87], v[116:119], v[180:183]
    ds_read_b64_tr_b16 v[66:67], v22 offset:17408
    v_mfma_f32_16x16x32_bf16 v[176:179], v[84:87], v[112:115], v[176:179]
    ds_read_b64_tr_b16 v[68:69], v23 offset:16384
    v_mfma_f32_16x16x32_bf16 v[160:163], v[80:83], v[112:115], v[160:163]
    ds_read_b64_tr_b16 v[70:71], v23 offset:17408
    v_mfma_f32_16x16x32_bf16 v[156:159], v[80:83], v[108:111], v[156:159]
    ds_read_b128 v[40:43], v18 offset:16384
    v_mfma_f32_16x16x32_bf16 v[172:175], v[84:87], v[108:111], v[172:175]
    ds_read_b128 v[44:47], v18 offset:18432
    v_mfma_f32_16x16x32_bf16 v[168:171], v[84:87], v[104:107], v[168:171]
    ds_read_b128 v[48:51], v18 offset:20480
    v_mfma_f32_16x16x32_bf16 v[152:155], v[80:83], v[104:107], v[152:155]
    ds_read_b128 v[52:55], v18 offset:22528
    v_mfma_f32_16x16x32_bf16 v[184:187], v[88:91], v[104:107], v[184:187]
    v_mfma_f32_16x16x32_bf16 v[200:203], v[92:95], v[104:107], v[200:203]
    v_mfma_f32_16x16x32_bf16 v[204:207], v[92:95], v[108:111], v[204:207]
    v_mfma_f32_16x16x32_bf16 v[188:191], v[88:91], v[108:111], v[188:191]
    v_mfma_f32_16x16x32_bf16 v[192:195], v[88:91], v[112:115], v[192:195]
    v_mfma_f32_16x16x32_bf16 v[208:211], v[92:95], v[112:115], v[208:211]
    v_mfma_f32_16x16x32_bf16 v[212:215], v[92:95], v[116:119], v[212:215]
    v_mfma_f32_16x16x32_bf16 v[196:199], v[88:91], v[116:119], v[196:199]
    v_mfma_f32_16x16x32_bf16 v[228:231], v[96:99], v[116:119], v[228:231]
    v_mfma_f32_16x16x32_bf16 v[244:247], v[100:103], v[116:119], v[244:247]
    v_mfma_f32_16x16x32_bf16 v[240:243], v[100:103], v[112:115], v[240:243]
    v_mfma_f32_16x16x32_bf16 v[224:227], v[96:99], v[112:115], v[224:227]
    v_mfma_f32_16x16x32_bf16 v[220:223], v[96:99], v[108:111], v[220:223]
    v_mfma_f32_16x16x32_bf16 v[236:239], v[100:103], v[108:111], v[236:239]
    v_mfma_f32_16x16x32_bf16 v[232:235], v[100:103], v[104:107], v[232:235]
    v_mfma_f32_16x16x32_bf16 v[216:219], v[96:99], v[104:107], v[216:219]
L_quip_kernela2_c1:
    s_waitcnt lgkmcnt(0)
    v_mfma_f32_16x16x32_bf16 v[120:123], v[24:27], v[56:59], v[120:123]
    ds_read_b128 v[72:75], v17 offset:16384
    v_mfma_f32_16x16x32_bf16 v[136:139], v[28:31], v[56:59], v[136:139]
    ds_read_b128 v[76:79], v17 offset:18432
    v_mfma_f32_16x16x32_bf16 v[140:143], v[28:31], v[60:63], v[140:143]
    ds_read_b128 v[80:83], v17 offset:20480
    v_mfma_f32_16x16x32_bf16 v[124:127], v[24:27], v[60:63], v[124:127]
    ds_read_b128 v[84:87], v17 offset:22528
    v_mfma_f32_16x16x32_bf16 v[128:131], v[24:27], v[64:67], v[128:131]
    ds_read_b64_tr_b16 v[104:105], v20 offset:24576
    v_mfma_f32_16x16x32_bf16 v[144:147], v[28:31], v[64:67], v[144:147]
    ds_read_b64_tr_b16 v[106:107], v20 offset:25600
    v_mfma_f32_16x16x32_bf16 v[148:151], v[28:31], v[68:71], v[148:151]
    ds_read_b64_tr_b16 v[108:109], v21 offset:24576
    v_mfma_f32_16x16x32_bf16 v[132:135], v[24:27], v[68:71], v[132:135]
    ds_read_b64_tr_b16 v[110:111], v21 offset:25600
    v_mfma_f32_16x16x32_bf16 v[164:167], v[32:35], v[68:71], v[164:167]
    ds_read_b64_tr_b16 v[112:113], v22 offset:24576
    v_mfma_f32_16x16x32_bf16 v[180:183], v[36:39], v[68:71], v[180:183]
    ds_read_b64_tr_b16 v[114:115], v22 offset:25600
    v_mfma_f32_16x16x32_bf16 v[176:179], v[36:39], v[64:67], v[176:179]
    ds_read_b64_tr_b16 v[116:117], v23 offset:24576
    v_mfma_f32_16x16x32_bf16 v[160:163], v[32:35], v[64:67], v[160:163]
    ds_read_b64_tr_b16 v[118:119], v23 offset:25600
    v_mfma_f32_16x16x32_bf16 v[156:159], v[32:35], v[60:63], v[156:159]
    ds_read_b128 v[88:91], v19 offset:16384
    v_mfma_f32_16x16x32_bf16 v[172:175], v[36:39], v[60:63], v[172:175]
    ds_read_b128 v[92:95], v19 offset:18432
    v_mfma_f32_16x16x32_bf16 v[168:171], v[36:39], v[56:59], v[168:171]
    ds_read_b128 v[96:99], v19 offset:20480
    v_mfma_f32_16x16x32_bf16 v[152:155], v[32:35], v[56:59], v[152:155]
    ds_read_b128 v[100:103], v19 offset:22528
    v_mfma_f32_16x16x32_bf16 v[184:187], v[40:43], v[56:59], v[184:187]
    s_add_u32 s57, s57, 1
    s_cmp_lt_u32 s57, 24
    v_mfma_f32_16x16x32_bf16 v[200:203], v[44:47], v[56:59], v[200:203]
    v_mfma_f32_16x16x32_bf16 v[204:207], v[44:47], v[60:63], v[204:207]
    v_mfma_f32_16x16x32_bf16 v[188:191], v[40:43], v[60:63], v[188:191]
    v_mfma_f32_16x16x32_bf16 v[192:195], v[40:43], v[64:67], v[192:195]
    v_mfma_f32_16x16x32_bf16 v[208:211], v[44:47], v[64:67], v[208:211]
    v_mfma_f32_16x16x32_bf16 v[212:215], v[44:47], v[68:71], v[212:215]
    v_mfma_f32_16x16x32_bf16 v[196:199], v[40:43], v[68:71], v[196:199]
    v_mfma_f32_16x16x32_bf16 v[228:231], v[48:51], v[68:71], v[228:231]
    v_mfma_f32_16x16x32_bf16 v[244:247], v[52:55], v[68:71], v[244:247]
    v_mfma_f32_16x16x32_bf16 v[240:243], v[52:55], v[64:67], v[240:243]
    v_mfma_f32_16x16x32_bf16 v[224:227], v[48:51], v[64:67], v[224:227]
    v_mfma_f32_16x16x32_bf16 v[220:223], v[48:51], v[60:63], v[220:223]
    v_mfma_f32_16x16x32_bf16 v[236:239], v[52:55], v[60:63], v[236:239]
    v_mfma_f32_16x16x32_bf16 v[232:235], v[52:55], v[56:59], v[232:235]
    v_mfma_f32_16x16x32_bf16 v[216:219], v[48:51], v[56:59], v[216:219]
L_quip_kernela2_m1:
    s_waitcnt lgkmcnt(0)
    s_barrier
    v_mfma_f32_16x16x32_bf16 v[120:123], v[72:75], v[104:107], v[120:123]
    ds_read_b128 v[24:27], v16 offset:32768
    v_mfma_f32_16x16x32_bf16 v[136:139], v[76:79], v[104:107], v[136:139]
    ds_read_b128 v[28:31], v16 offset:34816
    v_mfma_f32_16x16x32_bf16 v[140:143], v[76:79], v[108:111], v[140:143]
    ds_read_b128 v[32:35], v16 offset:36864
    v_mfma_f32_16x16x32_bf16 v[124:127], v[72:75], v[108:111], v[124:127]
    ds_read_b128 v[36:39], v16 offset:38912
    v_mfma_f32_16x16x32_bf16 v[128:131], v[72:75], v[112:115], v[128:131]
    ds_read_b64_tr_b16 v[56:57], v20 offset:32768
    v_mfma_f32_16x16x32_bf16 v[144:147], v[76:79], v[112:115], v[144:147]
    ds_read_b64_tr_b16 v[58:59], v20 offset:33792
    v_mfma_f32_16x16x32_bf16 v[148:151], v[76:79], v[116:119], v[148:151]
    ds_read_b64_tr_b16 v[60:61], v21 offset:32768
    v_mfma_f32_16x16x32_bf16 v[132:135], v[72:75], v[116:119], v[132:135]
    ds_read_b64_tr_b16 v[62:63], v21 offset:33792
    v_mfma_f32_16x16x32_bf16 v[164:167], v[80:83], v[116:119], v[164:167]
    ds_read_b64_tr_b16 v[64:65], v22 offset:32768
    v_mfma_f32_16x16x32_bf16 v[180:183], v[84:87], v[116:119], v[180:183]
    ds_read_b64_tr_b16 v[66:67], v22 offset:33792
    v_mfma_f32_16x16x32_bf16 v[176:179], v[84:87], v[112:115], v[176:179]
    ds_read_b64_tr_b16 v[68:69], v23 offset:32768
    v_mfma_f32_16x16x32_bf16 v[160:163], v[80:83], v[112:115], v[160:163]
    ds_read_b64_tr_b16 v[70:71], v23 offset:33792
    v_mfma_f32_16x16x32_bf16 v[156:159], v[80:83], v[108:111], v[156:159]
    ds_read_b128 v[40:43], v18 offset:32768
    v_mfma_f32_16x16x32_bf16 v[172:175], v[84:87], v[108:111], v[172:175]
    ds_read_b128 v[44:47], v18 offset:34816
    v_mfma_f32_16x16x32_bf16 v[168:171], v[84:87], v[104:107], v[168:171]
    ds_read_b128 v[48:51], v18 offset:36864
    v_mfma_f32_16x16x32_bf16 v[152:155], v[80:83], v[104:107], v[152:155]
    ds_read_b128 v[52:55], v18 offset:38912
    v_mfma_f32_16x16x32_bf16 v[184:187], v[88:91], v[104:107], v[184:187]
    v_mfma_f32_16x16x32_bf16 v[200:203], v[92:95], v[104:107], v[200:203]
    v_mfma_f32_16x16x32_bf16 v[204:207], v[92:95], v[108:111], v[204:207]
    v_mfma_f32_16x16x32_bf16 v[188:191], v[88:91], v[108:111], v[188:191]
    v_mfma_f32_16x16x32_bf16 v[192:195], v[88:91], v[112:115], v[192:195]
    v_mfma_f32_16x16x32_bf16 v[208:211], v[92:95], v[112:115], v[208:211]
    v_mfma_f32_16x16x32_bf16 v[212:215], v[92:95], v[116:119], v[212:215]
    v_mfma_f32_16x16x32_bf16 v[196:199], v[88:91], v[116:119], v[196:199]
    v_mfma_f32_16x16x32_bf16 v[228:231], v[96:99], v[116:119], v[228:231]
    v_mfma_f32_16x16x32_bf16 v[244:247], v[100:103], v[116:119], v[244:247]
    v_mfma_f32_16x16x32_bf16 v[240:243], v[100:103], v[112:115], v[240:243]
    v_mfma_f32_16x16x32_bf16 v[224:227], v[96:99], v[112:115], v[224:227]
    v_mfma_f32_16x16x32_bf16 v[220:223], v[96:99], v[108:111], v[220:223]
    v_mfma_f32_16x16x32_bf16 v[236:239], v[100:103], v[108:111], v[236:239]
    v_mfma_f32_16x16x32_bf16 v[232:235], v[100:103], v[104:107], v[232:235]
    v_mfma_f32_16x16x32_bf16 v[216:219], v[96:99], v[104:107], v[216:219]
L_quip_kernela2_c2:
    s_waitcnt lgkmcnt(0)
    v_mfma_f32_16x16x32_bf16 v[120:123], v[24:27], v[56:59], v[120:123]
    ds_read_b128 v[72:75], v17 offset:32768
    v_mfma_f32_16x16x32_bf16 v[136:139], v[28:31], v[56:59], v[136:139]
    ds_read_b128 v[76:79], v17 offset:34816
    v_mfma_f32_16x16x32_bf16 v[140:143], v[28:31], v[60:63], v[140:143]
    ds_read_b128 v[80:83], v17 offset:36864
    v_mfma_f32_16x16x32_bf16 v[124:127], v[24:27], v[60:63], v[124:127]
    ds_read_b128 v[84:87], v17 offset:38912
    v_mfma_f32_16x16x32_bf16 v[128:131], v[24:27], v[64:67], v[128:131]
    ds_read_b64_tr_b16 v[104:105], v20 offset:40960
    v_mfma_f32_16x16x32_bf16 v[144:147], v[28:31], v[64:67], v[144:147]
    ds_read_b64_tr_b16 v[106:107], v20 offset:41984
    v_mfma_f32_16x16x32_bf16 v[148:151], v[28:31], v[68:71], v[148:151]
    ds_read_b64_tr_b16 v[108:109], v21 offset:40960
    v_mfma_f32_16x16x32_bf16 v[132:135], v[24:27], v[68:71], v[132:135]
    ds_read_b64_tr_b16 v[110:111], v21 offset:41984
    v_mfma_f32_16x16x32_bf16 v[164:167], v[32:35], v[68:71], v[164:167]
    ds_read_b64_tr_b16 v[112:113], v22 offset:40960
    v_mfma_f32_16x16x32_bf16 v[180:183], v[36:39], v[68:71], v[180:183]
    ds_read_b64_tr_b16 v[114:115], v22 offset:41984
    v_mfma_f32_16x16x32_bf16 v[176:179], v[36:39], v[64:67], v[176:179]
    ds_read_b64_tr_b16 v[116:117], v23 offset:40960
    v_mfma_f32_16x16x32_bf16 v[160:163], v[32:35], v[64:67], v[160:163]
    ds_read_b64_tr_b16 v[118:119], v23 offset:41984
    v_mfma_f32_16x16x32_bf16 v[156:159], v[32:35], v[60:63], v[156:159]
    ds_read_b128 v[88:91], v19 offset:32768
    v_mfma_f32_16x16x32_bf16 v[172:175], v[36:39], v[60:63], v[172:175]
    ds_read_b128 v[92:95], v19 offset:34816
    v_mfma_f32_16x16x32_bf16 v[168:171], v[36:39], v[56:59], v[168:171]
    ds_read_b128 v[96:99], v19 offset:36864
    v_mfma_f32_16x16x32_bf16 v[152:155], v[32:35], v[56:59], v[152:155]
    ds_read_b128 v[100:103], v19 offset:38912
    v_mfma_f32_16x16x32_bf16 v[184:187], v[40:43], v[56:59], v[184:187]
    s_add_u32 s57, s57, 1
    s_cmp_lt_u32 s57, 24
    v_mfma_f32_16x16x32_bf16 v[200:203], v[44:47], v[56:59], v[200:203]
    v_mfma_f32_16x16x32_bf16 v[204:207], v[44:47], v[60:63], v[204:207]
    v_mfma_f32_16x16x32_bf16 v[188:191], v[40:43], v[60:63], v[188:191]
    v_mfma_f32_16x16x32_bf16 v[192:195], v[40:43], v[64:67], v[192:195]
    v_mfma_f32_16x16x32_bf16 v[208:211], v[44:47], v[64:67], v[208:211]
    v_mfma_f32_16x16x32_bf16 v[212:215], v[44:47], v[68:71], v[212:215]
    v_mfma_f32_16x16x32_bf16 v[196:199], v[40:43], v[68:71], v[196:199]
    v_mfma_f32_16x16x32_bf16 v[228:231], v[48:51], v[68:71], v[228:231]
    v_mfma_f32_16x16x32_bf16 v[244:247], v[52:55], v[68:71], v[244:247]
    v_mfma_f32_16x16x32_bf16 v[240:243], v[52:55], v[64:67], v[240:243]
    v_mfma_f32_16x16x32_bf16 v[224:227], v[48:51], v[64:67], v[224:227]
    v_mfma_f32_16x16x32_bf16 v[220:223], v[48:51], v[60:63], v[220:223]
    v_mfma_f32_16x16x32_bf16 v[236:239], v[52:55], v[60:63], v[236:239]
    v_mfma_f32_16x16x32_bf16 v[232:235], v[52:55], v[56:59], v[232:235]
    v_mfma_f32_16x16x32_bf16 v[216:219], v[48:51], v[56:59], v[216:219]
L_quip_kernela2_m2:
    s_waitcnt lgkmcnt(0)
    s_barrier
    v_mfma_f32_16x16x32_bf16 v[120:123], v[72:75], v[104:107], v[120:123]
    ds_read_b128 v[24:27], v16 offset:0
    v_mfma_f32_16x16x32_bf16 v[136:139], v[76:79], v[104:107], v[136:139]
    ds_read_b128 v[28:31], v16 offset:2048
    v_mfma_f32_16x16x32_bf16 v[140:143], v[76:79], v[108:111], v[140:143]
    ds_read_b128 v[32:35], v16 offset:4096
    v_mfma_f32_16x16x32_bf16 v[124:127], v[72:75], v[108:111], v[124:127]
    ds_read_b128 v[36:39], v16 offset:6144
    v_mfma_f32_16x16x32_bf16 v[128:131], v[72:75], v[112:115], v[128:131]
    ds_read_b64_tr_b16 v[56:57], v20 offset:0
    v_mfma_f32_16x16x32_bf16 v[144:147], v[76:79], v[112:115], v[144:147]
    ds_read_b64_tr_b16 v[58:59], v20 offset:1024
    v_mfma_f32_16x16x32_bf16 v[148:151], v[76:79], v[116:119], v[148:151]
    ds_read_b64_tr_b16 v[60:61], v21 offset:0
    v_mfma_f32_16x16x32_bf16 v[132:135], v[72:75], v[116:119], v[132:135]
    ds_read_b64_tr_b16 v[62:63], v21 offset:1024
    v_mfma_f32_16x16x32_bf16 v[164:167], v[80:83], v[116:119], v[164:167]
    ds_read_b64_tr_b16 v[64:65], v22 offset:0
    v_mfma_f32_16x16x32_bf16 v[180:183], v[84:87], v[116:119], v[180:183]
    ds_read_b64_tr_b16 v[66:67], v22 offset:1024
    v_mfma_f32_16x16x32_bf16 v[176:179], v[84:87], v[112:115], v[176:179]
    ds_read_b64_tr_b16 v[68:69], v23 offset:0
    v_mfma_f32_16x16x32_bf16 v[160:163], v[80:83], v[112:115], v[160:163]
    ds_read_b64_tr_b16 v[70:71], v23 offset:1024
    v_mfma_f32_16x16x32_bf16 v[156:159], v[80:83], v[108:111], v[156:159]
    ds_read_b128 v[40:43], v18 offset:0
    v_mfma_f32_16x16x32_bf16 v[172:175], v[84:87], v[108:111], v[172:175]
    ds_read_b128 v[44:47], v18 offset:2048
    v_mfma_f32_16x16x32_bf16 v[168:171], v[84:87], v[104:107], v[168:171]
    ds_read_b128 v[48:51], v18 offset:4096
    v_mfma_f32_16x16x32_bf16 v[152:155], v[80:83], v[104:107], v[152:155]
    ds_read_b128 v[52:55], v18 offset:6144
    v_mfma_f32_16x16x32_bf16 v[184:187], v[88:91], v[104:107], v[184:187]
    v_mfma_f32_16x16x32_bf16 v[200:203], v[92:95], v[104:107], v[200:203]
    v_mfma_f32_16x16x32_bf16 v[204:207], v[92:95], v[108:111], v[204:207]
    v_mfma_f32_16x16x32_bf16 v[188:191], v[88:91], v[108:111], v[188:191]
    v_mfma_f32_16x16x32_bf16 v[192:195], v[88:91], v[112:115], v[192:195]
    v_mfma_f32_16x16x32_bf16 v[208:211], v[92:95], v[112:115], v[208:211]
    v_mfma_f32_16x16x32_bf16 v[212:215], v[92:95], v[116:119], v[212:215]
    v_mfma_f32_16x16x32_bf16 v[196:199], v[88:91], v[116:119], v[196:199]
    v_mfma_f32_16x16x32_bf16 v[228:231], v[96:99], v[116:119], v[228:231]
    v_mfma_f32_16x16x32_bf16 v[244:247], v[100:103], v[116:119], v[244:247]
    v_mfma_f32_16x16x32_bf16 v[240:243], v[100:103], v[112:115], v[240:243]
    v_mfma_f32_16x16x32_bf16 v[224:227], v[96:99], v[112:115], v[224:227]
    v_mfma_f32_16x16x32_bf16 v[220:223], v[96:99], v[108:111], v[220:223]
    v_mfma_f32_16x16x32_bf16 v[236:239], v[100:103], v[108:111], v[236:239]
    v_mfma_f32_16x16x32_bf16 v[232:235], v[100:103], v[104:107], v[232:235]
    v_mfma_f32_16x16x32_bf16 v[216:219], v[96:99], v[104:107], v[216:219]
    s_cbranch_scc1 L_quip_kernela2_c0
    s_waitcnt lgkmcnt(0)
    v_mfma_f32_16x16x32_bf16 v[120:123], v[24:27], v[56:59], v[120:123]
    ds_read_b128 v[72:75], v17 offset:0
    v_mfma_f32_16x16x32_bf16 v[136:139], v[28:31], v[56:59], v[136:139]
    ds_read_b128 v[76:79], v17 offset:2048
    v_cvt_pk_bf16_f32 v184, v184, v185
    v_cvt_pk_bf16_f32 v185, v186, v187
    v_mfma_f32_16x16x32_bf16 v[140:143], v[28:31], v[60:63], v[140:143]
    ds_read_b128 v[80:83], v17 offset:4096
    v_mfma_f32_16x16x32_bf16 v[124:127], v[24:27], v[60:63], v[124:127]
    ds_read_b128 v[84:87], v17 offset:6144
    v_cvt_pk_bf16_f32 v186, v188, v189
    v_cvt_pk_bf16_f32 v187, v190, v191
    buffer_store_dwordx4 v[184:187], v13, s[32:35], s62 offen offset:0 sc1
    v_mfma_f32_16x16x32_bf16 v[128:131], v[24:27], v[64:67], v[128:131]
    ds_read_b64_tr_b16 v[104:105], v20 offset:8192
    v_mfma_f32_16x16x32_bf16 v[144:147], v[28:31], v[64:67], v[144:147]
    ds_read_b64_tr_b16 v[106:107], v20 offset:9216
    v_cvt_pk_bf16_f32 v192, v192, v193
    v_cvt_pk_bf16_f32 v193, v194, v195
    v_mfma_f32_16x16x32_bf16 v[148:151], v[28:31], v[68:71], v[148:151]
    ds_read_b64_tr_b16 v[108:109], v21 offset:8192
    v_mfma_f32_16x16x32_bf16 v[132:135], v[24:27], v[68:71], v[132:135]
    ds_read_b64_tr_b16 v[110:111], v21 offset:9216
    v_cvt_pk_bf16_f32 v194, v196, v197
    v_cvt_pk_bf16_f32 v195, v198, v199
    buffer_store_dwordx4 v[192:195], v13, s[32:35], s62 offen offset:1024 sc1
    v_mfma_f32_16x16x32_bf16 v[164:167], v[32:35], v[68:71], v[164:167]
    ds_read_b64_tr_b16 v[112:113], v22 offset:8192
    v_mfma_f32_16x16x32_bf16 v[180:183], v[36:39], v[68:71], v[180:183]
    ds_read_b64_tr_b16 v[114:115], v22 offset:9216
    v_cvt_pk_bf16_f32 v200, v200, v201
    v_cvt_pk_bf16_f32 v201, v202, v203
    v_mfma_f32_16x16x32_bf16 v[176:179], v[36:39], v[64:67], v[176:179]
    ds_read_b64_tr_b16 v[116:117], v23 offset:8192
    v_mfma_f32_16x16x32_bf16 v[160:163], v[32:35], v[64:67], v[160:163]
    ds_read_b64_tr_b16 v[118:119], v23 offset:9216
    v_cvt_pk_bf16_f32 v202, v204, v205
    v_cvt_pk_bf16_f32 v203, v206, v207
    buffer_store_dwordx4 v[200:203], v13, s[32:35], s62 offen offset:2048 sc1
    v_mfma_f32_16x16x32_bf16 v[156:159], v[32:35], v[60:63], v[156:159]
    v_mfma_f32_16x16x32_bf16 v[172:175], v[36:39], v[60:63], v[172:175]
    v_cvt_pk_bf16_f32 v208, v208, v209
    v_cvt_pk_bf16_f32 v209, v210, v211
    v_mfma_f32_16x16x32_bf16 v[168:171], v[36:39], v[56:59], v[168:171]
    v_mfma_f32_16x16x32_bf16 v[152:155], v[32:35], v[56:59], v[152:155]
    v_cvt_pk_bf16_f32 v210, v212, v213
    v_cvt_pk_bf16_f32 v211, v214, v215
    buffer_store_dwordx4 v[208:211], v13, s[32:35], s62 offen offset:3072 sc1
    s_waitcnt lgkmcnt(0)
    s_barrier
    v_mfma_f32_16x16x32_bf16 v[120:123], v[72:75], v[104:107], v[120:123]
    ds_read_b128 v[24:27], v16 offset:16384
    v_mfma_f32_16x16x32_bf16 v[136:139], v[76:79], v[104:107], v[136:139]
    ds_read_b128 v[28:31], v16 offset:18432
    s_add_u32 s62, s62, 4096
    v_cvt_pk_bf16_f32 v216, v216, v217
    v_cvt_pk_bf16_f32 v217, v218, v219
    v_mfma_f32_16x16x32_bf16 v[140:143], v[76:79], v[108:111], v[140:143]
    ds_read_b128 v[32:35], v16 offset:20480
    v_mfma_f32_16x16x32_bf16 v[124:127], v[72:75], v[108:111], v[124:127]
    ds_read_b128 v[36:39], v16 offset:22528
    v_cvt_pk_bf16_f32 v218, v220, v221
    v_cvt_pk_bf16_f32 v219, v222, v223
    buffer_store_dwordx4 v[216:219], v13, s[32:35], s62 offen offset:0 sc1
    v_mfma_f32_16x16x32_bf16 v[128:131], v[72:75], v[112:115], v[128:131]
    ds_read_b64_tr_b16 v[56:57], v20 offset:16384
    v_mfma_f32_16x16x32_bf16 v[144:147], v[76:79], v[112:115], v[144:147]
    ds_read_b64_tr_b16 v[58:59], v20 offset:17408
    v_cvt_pk_bf16_f32 v224, v224, v225
    v_cvt_pk_bf16_f32 v225, v226, v227
    v_mfma_f32_16x16x32_bf16 v[148:151], v[76:79], v[116:119], v[148:151]
    ds_read_b64_tr_b16 v[60:61], v21 offset:16384
    v_mfma_f32_16x16x32_bf16 v[132:135], v[72:75], v[116:119], v[132:135]
    ds_read_b64_tr_b16 v[62:63], v21 offset:17408
    v_cvt_pk_bf16_f32 v226, v228, v229
    v_cvt_pk_bf16_f32 v227, v230, v231
    buffer_store_dwordx4 v[224:227], v13, s[32:35], s62 offen offset:1024 sc1
    v_mfma_f32_16x16x32_bf16 v[164:167], v[80:83], v[116:119], v[164:167]
    ds_read_b64_tr_b16 v[64:65], v22 offset:16384
    v_mfma_f32_16x16x32_bf16 v[180:183], v[84:87], v[116:119], v[180:183]
    ds_read_b64_tr_b16 v[66:67], v22 offset:17408
    v_cvt_pk_bf16_f32 v232, v232, v233
    v_cvt_pk_bf16_f32 v233, v234, v235
    v_mfma_f32_16x16x32_bf16 v[176:179], v[84:87], v[112:115], v[176:179]
    ds_read_b64_tr_b16 v[68:69], v23 offset:16384
    v_mfma_f32_16x16x32_bf16 v[160:163], v[80:83], v[112:115], v[160:163]
    ds_read_b64_tr_b16 v[70:71], v23 offset:17408
    v_cvt_pk_bf16_f32 v234, v236, v237
    v_cvt_pk_bf16_f32 v235, v238, v239
    buffer_store_dwordx4 v[232:235], v13, s[32:35], s62 offen offset:2048 sc1
    v_mfma_f32_16x16x32_bf16 v[156:159], v[80:83], v[108:111], v[156:159]
    v_mfma_f32_16x16x32_bf16 v[172:175], v[84:87], v[108:111], v[172:175]
    v_cvt_pk_bf16_f32 v240, v240, v241
    v_cvt_pk_bf16_f32 v241, v242, v243
    v_mfma_f32_16x16x32_bf16 v[168:171], v[84:87], v[104:107], v[168:171]
    v_mfma_f32_16x16x32_bf16 v[152:155], v[80:83], v[104:107], v[152:155]
    v_cvt_pk_bf16_f32 v242, v244, v245
    v_cvt_pk_bf16_f32 v243, v246, v247
    buffer_store_dwordx4 v[240:243], v13, s[32:35], s62 offen offset:3072 sc1
    s_waitcnt lgkmcnt(0)
    v_mfma_f32_16x16x32_bf16 v[120:123], v[24:27], v[56:59], v[120:123]
    ds_read_b128 v[72:75], v17 offset:16384
    v_mfma_f32_16x16x32_bf16 v[136:139], v[28:31], v[56:59], v[136:139]
    ds_read_b128 v[76:79], v17 offset:18432
    v_mfma_f32_16x16x32_bf16 v[140:143], v[28:31], v[60:63], v[140:143]
    ds_read_b128 v[80:83], v17 offset:20480
    v_mfma_f32_16x16x32_bf16 v[124:127], v[24:27], v[60:63], v[124:127]
    ds_read_b128 v[84:87], v17 offset:22528
    v_mfma_f32_16x16x32_bf16 v[128:131], v[24:27], v[64:67], v[128:131]
    ds_read_b64_tr_b16 v[104:105], v20 offset:24576
    v_mfma_f32_16x16x32_bf16 v[144:147], v[28:31], v[64:67], v[144:147]
    ds_read_b64_tr_b16 v[106:107], v20 offset:25600
    v_mfma_f32_16x16x32_bf16 v[148:151], v[28:31], v[68:71], v[148:151]
    ds_read_b64_tr_b16 v[108:109], v21 offset:24576
    v_mfma_f32_16x16x32_bf16 v[132:135], v[24:27], v[68:71], v[132:135]
    ds_read_b64_tr_b16 v[110:111], v21 offset:25600
    v_mfma_f32_16x16x32_bf16 v[164:167], v[32:35], v[68:71], v[164:167]
    ds_read_b64_tr_b16 v[112:113], v22 offset:24576
    v_mfma_f32_16x16x32_bf16 v[180:183], v[36:39], v[68:71], v[180:183]
    ds_read_b64_tr_b16 v[114:115], v22 offset:25600
    v_mfma_f32_16x16x32_bf16 v[176:179], v[36:39], v[64:67], v[176:179]
    ds_read_b64_tr_b16 v[116:117], v23 offset:24576
    v_mfma_f32_16x16x32_bf16 v[160:163], v[32:35], v[64:67], v[160:163]
    ds_read_b64_tr_b16 v[118:119], v23 offset:25600
    v_mfma_f32_16x16x32_bf16 v[156:159], v[32:35], v[60:63], v[156:159]
    v_mfma_f32_16x16x32_bf16 v[172:175], v[36:39], v[60:63], v[172:175]
    v_mfma_f32_16x16x32_bf16 v[168:171], v[36:39], v[56:59], v[168:171]
    v_mfma_f32_16x16x32_bf16 v[152:155], v[32:35], v[56:59], v[152:155]
    s_waitcnt lgkmcnt(0)
    s_barrier
    v_mfma_f32_16x16x32_bf16 v[120:123], v[72:75], v[104:107], v[120:123]
    ds_read_b128 v[24:27], v16 offset:32768
    v_mfma_f32_16x16x32_bf16 v[136:139], v[76:79], v[104:107], v[136:139]
    ds_read_b128 v[28:31], v16 offset:34816
    v_mfma_f32_16x16x32_bf16 v[140:143], v[76:79], v[108:111], v[140:143]
    ds_read_b128 v[32:35], v16 offset:36864
    v_mfma_f32_16x16x32_bf16 v[124:127], v[72:75], v[108:111], v[124:127]
    ds_read_b128 v[36:39], v16 offset:38912
    v_mfma_f32_16x16x32_bf16 v[128:131], v[72:75], v[112:115], v[128:131]
    ds_read_b64_tr_b16 v[56:57], v20 offset:32768
    v_mfma_f32_16x16x32_bf16 v[144:147], v[76:79], v[112:115], v[144:147]
    ds_read_b64_tr_b16 v[58:59], v20 offset:33792
    v_mfma_f32_16x16x32_bf16 v[148:151], v[76:79], v[116:119], v[148:151]
    ds_read_b64_tr_b16 v[60:61], v21 offset:32768
    v_mfma_f32_16x16x32_bf16 v[132:135], v[72:75], v[116:119], v[132:135]
    ds_read_b64_tr_b16 v[62:63], v21 offset:33792
    v_mfma_f32_16x16x32_bf16 v[164:167], v[80:83], v[116:119], v[164:167]
    ds_read_b64_tr_b16 v[64:65], v22 offset:32768
    v_mfma_f32_16x16x32_bf16 v[180:183], v[84:87], v[116:119], v[180:183]
    ds_read_b64_tr_b16 v[66:67], v22 offset:33792
    v_mfma_f32_16x16x32_bf16 v[176:179], v[84:87], v[112:115], v[176:179]
    ds_read_b64_tr_b16 v[68:69], v23 offset:32768
    v_mfma_f32_16x16x32_bf16 v[160:163], v[80:83], v[112:115], v[160:163]
    ds_read_b64_tr_b16 v[70:71], v23 offset:33792
    v_mfma_f32_16x16x32_bf16 v[156:159], v[80:83], v[108:111], v[156:159]
    v_mfma_f32_16x16x32_bf16 v[172:175], v[84:87], v[108:111], v[172:175]
    v_mfma_f32_16x16x32_bf16 v[168:171], v[84:87], v[104:107], v[168:171]
    v_mfma_f32_16x16x32_bf16 v[152:155], v[80:83], v[104:107], v[152:155]
    s_waitcnt lgkmcnt(0)
    v_mfma_f32_16x16x32_bf16 v[120:123], v[24:27], v[56:59], v[120:123]
    ds_read_b128 v[72:75], v17 offset:32768
    v_mfma_f32_16x16x32_bf16 v[136:139], v[28:31], v[56:59], v[136:139]
    ds_read_b128 v[76:79], v17 offset:34816
    v_mfma_f32_16x16x32_bf16 v[140:143], v[28:31], v[60:63], v[140:143]
    ds_read_b128 v[80:83], v17 offset:36864
    v_mfma_f32_16x16x32_bf16 v[124:127], v[24:27], v[60:63], v[124:127]
    ds_read_b128 v[84:87], v17 offset:38912
    v_mfma_f32_16x16x32_bf16 v[128:131], v[24:27], v[64:67], v[128:131]
    ds_read_b64_tr_b16 v[104:105], v20 offset:40960
    v_mfma_f32_16x16x32_bf16 v[144:147], v[28:31], v[64:67], v[144:147]
    ds_read_b64_tr_b16 v[106:107], v20 offset:41984
    v_mfma_f32_16x16x32_bf16 v[148:151], v[28:31], v[68:71], v[148:151]
    ds_read_b64_tr_b16 v[108:109], v21 offset:40960
    v_mfma_f32_16x16x32_bf16 v[132:135], v[24:27], v[68:71], v[132:135]
    ds_read_b64_tr_b16 v[110:111], v21 offset:41984
    v_mfma_f32_16x16x32_bf16 v[164:167], v[32:35], v[68:71], v[164:167]
    ds_read_b64_tr_b16 v[112:113], v22 offset:40960
    v_mfma_f32_16x16x32_bf16 v[180:183], v[36:39], v[68:71], v[180:183]
    ds_read_b64_tr_b16 v[114:115], v22 offset:41984
    v_mfma_f32_16x16x32_bf16 v[176:179], v[36:39], v[64:67], v[176:179]
    ds_read_b64_tr_b16 v[116:117], v23 offset:40960
    v_mfma_f32_16x16x32_bf16 v[160:163], v[32:35], v[64:67], v[160:163]
    ds_read_b64_tr_b16 v[118:119], v23 offset:41984
    v_mfma_f32_16x16x32_bf16 v[156:159], v[32:35], v[60:63], v[156:159]
    v_mfma_f32_16x16x32_bf16 v[172:175], v[36:39], v[60:63], v[172:175]
    v_mfma_f32_16x16x32_bf16 v[168:171], v[36:39], v[56:59], v[168:171]
    v_mfma_f32_16x16x32_bf16 v[152:155], v[32:35], v[56:59], v[152:155]
    s_waitcnt vmcnt(0) lgkmcnt(0)
    s_barrier
    s_cmp_eq_u32 s43, 0
    s_cbranch_scc0 L_pfxc
    v_mov_b32 v10, 0
    v_mov_b32 v11, s65
    s_mov_b64 exec, 1
    buffer_store_dword v11, v10, s[32:35], s64 offen sc1
    s_mov_b64 exec, -1
L_pfxc:
    v_mfma_f32_16x16x32_bf16 v[120:123], v[72:75], v[104:107], v[120:123]
    ds_read_b128 v[24:27], v16 offset:0
    v_mfma_f32_16x16x32_bf16 v[136:139], v[76:79], v[104:107], v[136:139]
    ds_read_b128 v[28:31], v16 offset:2048
    v_mfma_f32_16x16x32_bf16 v[140:143], v[76:79], v[108:111], v[140:143]
    ds_read_b128 v[32:35], v16 offset:4096
    v_mfma_f32_16x16x32_bf16 v[124:127], v[72:75], v[108:111], v[124:127]
    ds_read_b128 v[36:39], v16 offset:6144
    v_mfma_f32_16x16x32_bf16 v[128:131], v[72:75], v[112:115], v[128:131]
    ds_read_b64_tr_b16 v[56:57], v20 offset:0
    v_mfma_f32_16x16x32_bf16 v[144:147], v[76:79], v[112:115], v[144:147]
    ds_read_b64_tr_b16 v[58:59], v20 offset:1024
    v_mfma_f32_16x16x32_bf16 v[148:151], v[76:79], v[116:119], v[148:151]
    ds_read_b64_tr_b16 v[60:61], v21 offset:0
    v_mfma_f32_16x16x32_bf16 v[132:135], v[72:75], v[116:119], v[132:135]
    ds_read_b64_tr_b16 v[62:63], v21 offset:1024
    v_mfma_f32_16x16x32_bf16 v[164:167], v[80:83], v[116:119], v[164:167]
    ds_read_b64_tr_b16 v[64:65], v22 offset:0
    v_mfma_f32_16x16x32_bf16 v[180:183], v[84:87], v[116:119], v[180:183]
    ds_read_b64_tr_b16 v[66:67], v22 offset:1024
    v_mfma_f32_16x16x32_bf16 v[176:179], v[84:87], v[112:115], v[176:179]
    ds_read_b64_tr_b16 v[68:69], v23 offset:0
    v_mfma_f32_16x16x32_bf16 v[160:163], v[80:83], v[112:115], v[160:163]
    ds_read_b64_tr_b16 v[70:71], v23 offset:1024
    v_mfma_f32_16x16x32_bf16 v[156:159], v[80:83], v[108:111], v[156:159]
    v_mfma_f32_16x16x32_bf16 v[172:175], v[84:87], v[108:111], v[172:175]
    v_mfma_f32_16x16x32_bf16 v[168:171], v[84:87], v[104:107], v[168:171]
    v_mfma_f32_16x16x32_bf16 v[152:155], v[80:83], v[104:107], v[152:155]
    s_waitcnt lgkmcnt(0)
    v_mfma_f32_16x16x32_bf16 v[120:123], v[24:27], v[56:59], v[120:123]
    ds_read_b128 v[72:75], v17 offset:0
    v_mfma_f32_16x16x32_bf16 v[136:139], v[28:31], v[56:59], v[136:139]
    ds_read_b128 v[76:79], v17 offset:2048
    v_mfma_f32_16x16x32_bf16 v[140:143], v[28:31], v[60:63], v[140:143]
    ds_read_b128 v[80:83], v17 offset:4096
    v_mfma_f32_16x16x32_bf16 v[124:127], v[24:27], v[60:63], v[124:127]
    ds_read_b128 v[84:87], v17 offset:6144
    v_mfma_f32_16x16x32_bf16 v[128:131], v[24:27], v[64:67], v[128:131]
    ds_read_b64_tr_b16 v[104:105], v20 offset:8192
    v_mfma_f32_16x16x32_bf16 v[144:147], v[28:31], v[64:67], v[144:147]
    ds_read_b64_tr_b16 v[106:107], v20 offset:9216
    v_mfma_f32_16x16x32_bf16 v[148:151], v[28:31], v[68:71], v[148:151]
    ds_read_b64_tr_b16 v[108:109], v21 offset:8192
    v_mfma_f32_16x16x32_bf16 v[132:135], v[24:27], v[68:71], v[132:135]
    ds_read_b64_tr_b16 v[110:111], v21 offset:9216
    v_mfma_f32_16x16x32_bf16 v[164:167], v[32:35], v[68:71], v[164:167]
    ds_read_b64_tr_b16 v[112:113], v22 offset:8192
    v_mfma_f32_16x16x32_bf16 v[180:183], v[36:39], v[68:71], v[180:183]
    ds_read_b64_tr_b16 v[114:115], v22 offset:9216
    v_mfma_f32_16x16x32_bf16 v[176:179], v[36:39], v[64:67], v[176:179]
    ds_read_b64_tr_b16 v[116:117], v23 offset:8192
    v_mfma_f32_16x16x32_bf16 v[160:163], v[32:35], v[64:67], v[160:163]
    ds_read_b64_tr_b16 v[118:119], v23 offset:9216
    v_mfma_f32_16x16x32_bf16 v[156:159], v[32:35], v[60:63], v[156:159]
    v_mfma_f32_16x16x32_bf16 v[172:175], v[36:39], v[60:63], v[172:175]
    v_mfma_f32_16x16x32_bf16 v[168:171], v[36:39], v[56:59], v[168:171]
    v_mfma_f32_16x16x32_bf16 v[152:155], v[32:35], v[56:59], v[152:155]
    s_waitcnt lgkmcnt(0)
    s_barrier
    v_mfma_f32_16x16x32_bf16 v[120:123], v[72:75], v[104:107], v[120:123]
    ds_read_b128 v[24:27], v16 offset:16384
    v_mfma_f32_16x16x32_bf16 v[136:139], v[76:79], v[104:107], v[136:139]
    ds_read_b128 v[28:31], v16 offset:18432
    v_mfma_f32_16x16x32_bf16 v[140:143], v[76:79], v[108:111], v[140:143]
    ds_read_b128 v[32:35], v16 offset:20480
    v_mfma_f32_16x16x32_bf16 v[124:127], v[72:75], v[108:111], v[124:127]
    ds_read_b128 v[36:39], v16 offset:22528
    v_mfma_f32_16x16x32_bf16 v[128:131], v[72:75], v[112:115], v[128:131]
    ds_read_b64_tr_b16 v[56:57], v20 offset:16384
    v_mfma_f32_16x16x32_bf16 v[144:147], v[76:79], v[112:115], v[144:147]
    ds_read_b64_tr_b16 v[58:59], v20 offset:17408
    v_mfma_f32_16x16x32_bf16 v[148:151], v[76:79], v[116:119], v[148:151]
    ds_read_b64_tr_b16 v[60:61], v21 offset:16384
    v_mfma_f32_16x16x32_bf16 v[132:135], v[72:75], v[116:119], v[132:135]
    ds_read_b64_tr_b16 v[62:63], v21 offset:17408
    v_mfma_f32_16x16x32_bf16 v[164:167], v[80:83], v[116:119], v[164:167]
    ds_read_b64_tr_b16 v[64:65], v22 offset:16384
    v_mfma_f32_16x16x32_bf16 v[180:183], v[84:87], v[116:119], v[180:183]
    ds_read_b64_tr_b16 v[66:67], v22 offset:17408
    v_mfma_f32_16x16x32_bf16 v[176:179], v[84:87], v[112:115], v[176:179]
    ds_read_b64_tr_b16 v[68:69], v23 offset:16384
    v_mfma_f32_16x16x32_bf16 v[160:163], v[80:83], v[112:115], v[160:163]
    ds_read_b64_tr_b16 v[70:71], v23 offset:17408
    v_mfma_f32_16x16x32_bf16 v[156:159], v[80:83], v[108:111], v[156:159]
    v_mfma_f32_16x16x32_bf16 v[172:175], v[84:87], v[108:111], v[172:175]
    v_mfma_f32_16x16x32_bf16 v[168:171], v[84:87], v[104:107], v[168:171]
    v_mfma_f32_16x16x32_bf16 v[152:155], v[80:83], v[104:107], v[152:155]
    s_waitcnt lgkmcnt(0)
    v_mfma_f32_16x16x32_bf16 v[120:123], v[24:27], v[56:59], v[120:123]
    ds_read_b128 v[72:75], v17 offset:16384
    v_mfma_f32_16x16x32_bf16 v[136:139], v[28:31], v[56:59], v[136:139]
    ds_read_b128 v[76:79], v17 offset:18432
    v_mfma_f32_16x16x32_bf16 v[140:143], v[28:31], v[60:63], v[140:143]
    ds_read_b128 v[80:83], v17 offset:20480
    v_mfma_f32_16x16x32_bf16 v[124:127], v[24:27], v[60:63], v[124:127]
    ds_read_b128 v[84:87], v17 offset:22528
    v_mfma_f32_16x16x32_bf16 v[128:131], v[24:27], v[64:67], v[128:131]
    ds_read_b64_tr_b16 v[104:105], v20 offset:24576
    v_mfma_f32_16x16x32_bf16 v[144:147], v[28:31], v[64:67], v[144:147]
    ds_read_b64_tr_b16 v[106:107], v20 offset:25600
    v_mfma_f32_16x16x32_bf16 v[148:151], v[28:31], v[68:71], v[148:151]
    ds_read_b64_tr_b16 v[108:109], v21 offset:24576
    v_mfma_f32_16x16x32_bf16 v[132:135], v[24:27], v[68:71], v[132:135]
    ds_read_b64_tr_b16 v[110:111], v21 offset:25600
    v_mfma_f32_16x16x32_bf16 v[164:167], v[32:35], v[68:71], v[164:167]
    ds_read_b64_tr_b16 v[112:113], v22 offset:24576
    v_mfma_f32_16x16x32_bf16 v[180:183], v[36:39], v[68:71], v[180:183]
    ds_read_b64_tr_b16 v[114:115], v22 offset:25600
    v_mfma_f32_16x16x32_bf16 v[176:179], v[36:39], v[64:67], v[176:179]
    ds_read_b64_tr_b16 v[116:117], v23 offset:24576
    v_mfma_f32_16x16x32_bf16 v[160:163], v[32:35], v[64:67], v[160:163]
    ds_read_b64_tr_b16 v[118:119], v23 offset:25600
    v_mfma_f32_16x16x32_bf16 v[156:159], v[32:35], v[60:63], v[156:159]
    v_mfma_f32_16x16x32_bf16 v[172:175], v[36:39], v[60:63], v[172:175]
    v_mfma_f32_16x16x32_bf16 v[168:171], v[36:39], v[56:59], v[168:171]
    v_mfma_f32_16x16x32_bf16 v[152:155], v[32:35], v[56:59], v[152:155]
    s_waitcnt lgkmcnt(0)
    s_barrier
    v_mfma_f32_16x16x32_bf16 v[120:123], v[72:75], v[104:107], v[120:123]
    ds_read_b128 v[24:27], v16 offset:32768
    v_mfma_f32_16x16x32_bf16 v[136:139], v[76:79], v[104:107], v[136:139]
    ds_read_b128 v[28:31], v16 offset:34816
    v_mfma_f32_16x16x32_bf16 v[140:143], v[76:79], v[108:111], v[140:143]
    ds_read_b128 v[32:35], v16 offset:36864
    v_mfma_f32_16x16x32_bf16 v[124:127], v[72:75], v[108:111], v[124:127]
    ds_read_b128 v[36:39], v16 offset:38912
    v_mfma_f32_16x16x32_bf16 v[128:131], v[72:75], v[112:115], v[128:131]
    ds_read_b64_tr_b16 v[56:57], v20 offset:32768
    v_mfma_f32_16x16x32_bf16 v[144:147], v[76:79], v[112:115], v[144:147]
    ds_read_b64_tr_b16 v[58:59], v20 offset:33792
    v_mfma_f32_16x16x32_bf16 v[148:151], v[76:79], v[116:119], v[148:151]
    ds_read_b64_tr_b16 v[60:61], v21 offset:32768
    v_mfma_f32_16x16x32_bf16 v[132:135], v[72:75], v[116:119], v[132:135]
    ds_read_b64_tr_b16 v[62:63], v21 offset:33792
    v_mfma_f32_16x16x32_bf16 v[164:167], v[80:83], v[116:119], v[164:167]
    ds_read_b64_tr_b16 v[64:65], v22 offset:32768
    v_mfma_f32_16x16x32_bf16 v[180:183], v[84:87], v[116:119], v[180:183]
    ds_read_b64_tr_b16 v[66:67], v22 offset:33792
    v_mfma_f32_16x16x32_bf16 v[176:179], v[84:87], v[112:115], v[176:179]
    ds_read_b64_tr_b16 v[68:69], v23 offset:32768
    v_mfma_f32_16x16x32_bf16 v[160:163], v[80:83], v[112:115], v[160:163]
    ds_read_b64_tr_b16 v[70:71], v23 offset:33792
    v_mfma_f32_16x16x32_bf16 v[156:159], v[80:83], v[108:111], v[156:159]
    v_mfma_f32_16x16x32_bf16 v[172:175], v[84:87], v[108:111], v[172:175]
    v_mfma_f32_16x16x32_bf16 v[168:171], v[84:87], v[104:107], v[168:171]
    v_mfma_f32_16x16x32_bf16 v[152:155], v[80:83], v[104:107], v[152:155]
    s_waitcnt lgkmcnt(0)
    v_mfma_f32_16x16x32_bf16 v[120:123], v[24:27], v[56:59], v[120:123]
    ds_read_b128 v[72:75], v17 offset:32768
    v_mfma_f32_16x16x32_bf16 v[136:139], v[28:31], v[56:59], v[136:139]
    ds_read_b128 v[76:79], v17 offset:34816
    v_mfma_f32_16x16x32_bf16 v[140:143], v[28:31], v[60:63], v[140:143]
    ds_read_b128 v[80:83], v17 offset:36864
    v_mfma_f32_16x16x32_bf16 v[124:127], v[24:27], v[60:63], v[124:127]
    ds_read_b128 v[84:87], v17 offset:38912
    v_mfma_f32_16x16x32_bf16 v[128:131], v[24:27], v[64:67], v[128:131]
    ds_read_b64_tr_b16 v[104:105], v20 offset:40960
    v_mfma_f32_16x16x32_bf16 v[144:147], v[28:31], v[64:67], v[144:147]
    ds_read_b64_tr_b16 v[106:107], v20 offset:41984
    v_mfma_f32_16x16x32_bf16 v[148:151], v[28:31], v[68:71], v[148:151]
    ds_read_b64_tr_b16 v[108:109], v21 offset:40960
    v_mfma_f32_16x16x32_bf16 v[132:135], v[24:27], v[68:71], v[132:135]
    ds_read_b64_tr_b16 v[110:111], v21 offset:41984
    v_mfma_f32_16x16x32_bf16 v[164:167], v[32:35], v[68:71], v[164:167]
    ds_read_b64_tr_b16 v[112:113], v22 offset:40960
    v_mfma_f32_16x16x32_bf16 v[180:183], v[36:39], v[68:71], v[180:183]
    ds_read_b64_tr_b16 v[114:115], v22 offset:41984
    v_mfma_f32_16x16x32_bf16 v[176:179], v[36:39], v[64:67], v[176:179]
    ds_read_b64_tr_b16 v[116:117], v23 offset:40960
    v_mfma_f32_16x16x32_bf16 v[160:163], v[32:35], v[64:67], v[160:163]
    ds_read_b64_tr_b16 v[118:119], v23 offset:41984
    v_mfma_f32_16x16x32_bf16 v[156:159], v[32:35], v[60:63], v[156:159]
    v_mfma_f32_16x16x32_bf16 v[172:175], v[36:39], v[60:63], v[172:175]
    v_mfma_f32_16x16x32_bf16 v[168:171], v[36:39], v[56:59], v[168:171]
    v_mfma_f32_16x16x32_bf16 v[152:155], v[32:35], v[56:59], v[152:155]
    s_waitcnt lgkmcnt(0)
    s_barrier
    v_mfma_f32_16x16x32_bf16 v[120:123], v[72:75], v[104:107], v[120:123]
    ds_read_b128 v[24:27], v16 offset:0
    v_mfma_f32_16x16x32_bf16 v[136:139], v[76:79], v[104:107], v[136:139]
    ds_read_b128 v[28:31], v16 offset:2048
    buffer_load_dwordx4 v[184:187], v13, s[32:35], s63 offen offset:0 sc1
    v_mfma_f32_16x16x32_bf16 v[140:143], v[76:79], v[108:111], v[140:143]
    ds_read_b128 v[32:35], v16 offset:4096
    v_mfma_f32_16x16x32_bf16 v[124:127], v[72:75], v[108:111], v[124:127]
    ds_read_b128 v[36:39], v16 offset:6144
    v_mfma_f32_16x16x32_bf16 v[128:131], v[72:75], v[112:115], v[128:131]
    ds_read_b64_tr_b16 v[56:57], v20 offset:0
    v_mfma_f32_16x16x32_bf16 v[144:147], v[76:79], v[112:115], v[144:147]
    ds_read_b64_tr_b16 v[58:59], v20 offset:1024
    buffer_load_dwordx4 v[188:191], v13, s[32:35], s63 offen offset:1024 sc1
    v_mfma_f32_16x16x32_bf16 v[148:151], v[76:79], v[116:119], v[148:151]
    ds_read_b64_tr_b16 v[60:61], v21 offset:0
    v_mfma_f32_16x16x32_bf16 v[132:135], v[72:75], v[116:119], v[132:135]
    ds_read_b64_tr_b16 v[62:63], v21 offset:1024
    v_mfma_f32_16x16x32_bf16 v[164:167], v[80:83], v[116:119], v[164:167]
    ds_read_b64_tr_b16 v[64:65], v22 offset:0
    v_mfma_f32_16x16x32_bf16 v[180:183], v[84:87], v[116:119], v[180:183]
    ds_read_b64_tr_b16 v[66:67], v22 offset:1024
    buffer_load_dwordx4 v[192:195], v13, s[32:35], s63 offen offset:2048 sc1
    v_mfma_f32_16x16x32_bf16 v[176:179], v[84:87], v[112:115], v[176:179]
    ds_read_b64_tr_b16 v[68:69], v23 offset:0
    v_mfma_f32_16x16x32_bf16 v[160:163], v[80:83], v[112:115], v[160:163]
    ds_read_b64_tr_b16 v[70:71], v23 offset:1024
    v_mfma_f32_16x16x32_bf16 v[156:159], v[80:83], v[108:111], v[156:159]
    v_mfma_f32_16x16x32_bf16 v[172:175], v[84:87], v[108:111], v[172:175]
    buffer_load_dwordx4 v[196:199], v13, s[32:35], s63 offen offset:3072 sc1
    v_mfma_f32_16x16x32_bf16 v[168:171], v[84:87], v[104:107], v[168:171]
    v_mfma_f32_16x16x32_bf16 v[152:155], v[80:83], v[104:107], v[152:155]
    s_waitcnt lgkmcnt(0)
    v_mfma_f32_16x16x32_bf16 v[120:123], v[24:27], v[56:59], v[120:123]
    ds_read_b128 v[72:75], v17 offset:0
    v_mfma_f32_16x16x32_bf16 v[136:139], v[28:31], v[56:59], v[136:139]
    ds_read_b128 v[76:79], v17 offset:2048
    s_add_u32 s63, s63, 4096
    buffer_load_dwordx4 v[200:203], v13, s[32:35], s63 offen offset:0 sc1
    v_mfma_f32_16x16x32_bf16 v[140:143], v[28:31], v[60:63], v[140:143]
    ds_read_b128 v[80:83], v17 offset:4096
    v_mfma_f32_16x16x32_bf16 v[124:127], v[24:27], v[60:63], v[124:127]
    ds_read_b128 v[84:87], v17 offset:6144
    v_mfma_f32_16x16x32_bf16 v[128:131], v[24:27], v[64:67], v[128:131]
    ds_read_b64_tr_b16 v[104:105], v20 offset:8192
    v_mfma_f32_16x16x32_bf16 v[144:147], v[28:31], v[64:67], v[144:147]
    ds_read_b64_tr_b16 v[106:107], v20 offset:9216
    buffer_load_dwordx4 v[204:207], v13, s[32:35], s63 offen offset:1024 sc1
    v_mfma_f32_16x16x32_bf16 v[148:151], v[28:31], v[68:71], v[148:151]
    ds_read_b64_tr_b16 v[108:109], v21 offset:8192
    v_mfma_f32_16x16x32_bf16 v[132:135], v[24:27], v[68:71], v[132:135]
    ds_read_b64_tr_b16 v[110:111], v21 offset:9216
    v_mfma_f32_16x16x32_bf16 v[164:167], v[32:35], v[68:71], v[164:167]
    ds_read_b64_tr_b16 v[112:113], v22 offset:8192
    v_mfma_f32_16x16x32_bf16 v[180:183], v[36:39], v[68:71], v[180:183]
    ds_read_b64_tr_b16 v[114:115], v22 offset:9216
    buffer_load_dwordx4 v[208:211], v13, s[32:35], s63 offen offset:2048 sc1
    v_mfma_f32_16x16x32_bf16 v[176:179], v[36:39], v[64:67], v[176:179]
    ds_read_b64_tr_b16 v[116:117], v23 offset:8192
    v_mfma_f32_16x16x32_bf16 v[160:163], v[32:35], v[64:67], v[160:163]
    ds_read_b64_tr_b16 v[118:119], v23 offset:9216
    v_mfma_f32_16x16x32_bf16 v[156:159], v[32:35], v[60:63], v[156:159]
    v_mfma_f32_16x16x32_bf16 v[172:175], v[36:39], v[60:63], v[172:175]
    buffer_load_dwordx4 v[212:215], v13, s[32:35], s63 offen offset:3072 sc1
    v_mfma_f32_16x16x32_bf16 v[168:171], v[36:39], v[56:59], v[168:171]
    v_mfma_f32_16x16x32_bf16 v[152:155], v[32:35], v[56:59], v[152:155]
    s_waitcnt lgkmcnt(0)
    s_barrier
    v_mfma_f32_16x16x32_bf16 v[120:123], v[72:75], v[104:107], v[120:123]
    ds_read_b128 v[24:27], v16 offset:16384
    v_mfma_f32_16x16x32_bf16 v[136:139], v[76:79], v[104:107], v[136:139]
    ds_read_b128 v[28:31], v16 offset:18432
    v_mfma_f32_16x16x32_bf16 v[140:143], v[76:79], v[108:111], v[140:143]
    ds_read_b128 v[32:35], v16 offset:20480
    v_mfma_f32_16x16x32_bf16 v[124:127], v[72:75], v[108:111], v[124:127]
    ds_read_b128 v[36:39], v16 offset:22528
    v_mfma_f32_16x16x32_bf16 v[128:131], v[72:75], v[112:115], v[128:131]
    ds_read_b64_tr_b16 v[56:57], v20 offset:16384
    v_mfma_f32_16x16x32_bf16 v[144:147], v[76:79], v[112:115], v[144:147]
    ds_read_b64_tr_b16 v[58:59], v20 offset:17408
    v_mfma_f32_16x16x32_bf16 v[148:151], v[76:79], v[116:119], v[148:151]
    ds_read_b64_tr_b16 v[60:61], v21 offset:16384
    v_mfma_f32_16x16x32_bf16 v[132:135], v[72:75], v[116:119], v[132:135]
    ds_read_b64_tr_b16 v[62:63], v21 offset:17408
    v_mfma_f32_16x16x32_bf16 v[164:167], v[80:83], v[116:119], v[164:167]
    ds_read_b64_tr_b16 v[64:65], v22 offset:16384
    v_mfma_f32_16x16x32_bf16 v[180:183], v[84:87], v[116:119], v[180:183]
    ds_read_b64_tr_b16 v[66:67], v22 offset:17408
    v_mfma_f32_16x16x32_bf16 v[176:179], v[84:87], v[112:115], v[176:179]
    ds_read_b64_tr_b16 v[68:69], v23 offset:16384
    v_mfma_f32_16x16x32_bf16 v[160:163], v[80:83], v[112:115], v[160:163]
    ds_read_b64_tr_b16 v[70:71], v23 offset:17408
    v_mfma_f32_16x16x32_bf16 v[156:159], v[80:83], v[108:111], v[156:159]
    v_mfma_f32_16x16x32_bf16 v[172:175], v[84:87], v[108:111], v[172:175]
    v_mfma_f32_16x16x32_bf16 v[168:171], v[84:87], v[104:107], v[168:171]
    v_mfma_f32_16x16x32_bf16 v[152:155], v[80:83], v[104:107], v[152:155]
    s_waitcnt lgkmcnt(0)
    v_mfma_f32_16x16x32_bf16 v[120:123], v[24:27], v[56:59], v[120:123]
    ds_read_b128 v[72:75], v17 offset:16384
    v_mfma_f32_16x16x32_bf16 v[136:139], v[28:31], v[56:59], v[136:139]
    ds_read_b128 v[76:79], v17 offset:18432
    v_mfma_f32_16x16x32_bf16 v[140:143], v[28:31], v[60:63], v[140:143]
    ds_read_b128 v[80:83], v17 offset:20480
    v_mfma_f32_16x16x32_bf16 v[124:127], v[24:27], v[60:63], v[124:127]
    ds_read_b128 v[84:87], v17 offset:22528
    v_mfma_f32_16x16x32_bf16 v[128:131], v[24:27], v[64:67], v[128:131]
    ds_read_b64_tr_b16 v[104:105], v20 offset:24576
    v_mfma_f32_16x16x32_bf16 v[144:147], v[28:31], v[64:67], v[144:147]
    ds_read_b64_tr_b16 v[106:107], v20 offset:25600
    v_mfma_f32_16x16x32_bf16 v[148:151], v[28:31], v[68:71], v[148:151]
    ds_read_b64_tr_b16 v[108:109], v21 offset:24576
    v_mfma_f32_16x16x32_bf16 v[132:135], v[24:27], v[68:71], v[132:135]
    ds_read_b64_tr_b16 v[110:111], v21 offset:25600
    v_mfma_f32_16x16x32_bf16 v[164:167], v[32:35], v[68:71], v[164:167]
    ds_read_b64_tr_b16 v[112:113], v22 offset:24576
    v_mfma_f32_16x16x32_bf16 v[180:183], v[36:39], v[68:71], v[180:183]
    ds_read_b64_tr_b16 v[114:115], v22 offset:25600
    v_mfma_f32_16x16x32_bf16 v[176:179], v[36:39], v[64:67], v[176:179]
    ds_read_b64_tr_b16 v[116:117], v23 offset:24576
    v_mfma_f32_16x16x32_bf16 v[160:163], v[32:35], v[64:67], v[160:163]
    ds_read_b64_tr_b16 v[118:119], v23 offset:25600
    v_mfma_f32_16x16x32_bf16 v[156:159], v[32:35], v[60:63], v[156:159]
    v_mfma_f32_16x16x32_bf16 v[172:175], v[36:39], v[60:63], v[172:175]
    v_mfma_f32_16x16x32_bf16 v[168:171], v[36:39], v[56:59], v[168:171]
    v_mfma_f32_16x16x32_bf16 v[152:155], v[32:35], v[56:59], v[152:155]
    s_waitcnt lgkmcnt(0)
    s_barrier
    v_mfma_f32_16x16x32_bf16 v[120:123], v[72:75], v[104:107], v[120:123]
    v_mfma_f32_16x16x32_bf16 v[136:139], v[76:79], v[104:107], v[136:139]
    v_mfma_f32_16x16x32_bf16 v[140:143], v[76:79], v[108:111], v[140:143]
    v_mfma_f32_16x16x32_bf16 v[124:127], v[72:75], v[108:111], v[124:127]
    v_mfma_f32_16x16x32_bf16 v[128:131], v[72:75], v[112:115], v[128:131]
    v_mfma_f32_16x16x32_bf16 v[144:147], v[76:79], v[112:115], v[144:147]
    v_mfma_f32_16x16x32_bf16 v[148:151], v[76:79], v[116:119], v[148:151]
    v_mfma_f32_16x16x32_bf16 v[132:135], v[72:75], v[116:119], v[132:135]
    v_mfma_f32_16x16x32_bf16 v[164:167], v[80:83], v[116:119], v[164:167]
    v_mfma_f32_16x16x32_bf16 v[180:183], v[84:87], v[116:119], v[180:183]
    v_mfma_f32_16x16x32_bf16 v[176:179], v[84:87], v[112:115], v[176:179]
    v_mfma_f32_16x16x32_bf16 v[160:163], v[80:83], v[112:115], v[160:163]
    v_mfma_f32_16x16x32_bf16 v[156:159], v[80:83], v[108:111], v[156:159]
    v_mfma_f32_16x16x32_bf16 v[172:175], v[84:87], v[108:111], v[172:175]
    v_mfma_f32_16x16x32_bf16 v[168:171], v[84:87], v[104:107], v[168:171]
    v_mfma_f32_16x16x32_bf16 v[152:155], v[80:83], v[104:107], v[152:155]
    v_mov_b32 v24, 0
    v_mov_b32 v25, 0
    v_mov_b32 v26, v7
    v_mov_b32 v27, v8
    v_mov_b32 v28, 0
    v_mov_b32 v29, 0
    s_nop 0
    s_waitcnt vmcnt(0)
    v_mfma_f32_16x16x32_bf16 v[120:123], v[26:29], v[184:187], v[120:123]
    v_mfma_f32_16x16x32_bf16 v[124:127], v[24:27], v[184:187], v[124:127]
    v_mfma_f32_16x16x32_bf16 v[128:131], v[26:29], v[188:191], v[128:131]
    v_mfma_f32_16x16x32_bf16 v[132:135], v[24:27], v[188:191], v[132:135]
    v_mfma_f32_16x16x32_bf16 v[136:139], v[26:29], v[192:195], v[136:139]
    v_mfma_f32_16x16x32_bf16 v[140:143], v[24:27], v[192:195], v[140:143]
    v_mfma_f32_16x16x32_bf16 v[144:147], v[26:29], v[196:199], v[144:147]
    v_mfma_f32_16x16x32_bf16 v[148:151], v[24:27], v[196:199], v[148:151]
    v_mfma_f32_16x16x32_bf16 v[152:155], v[26:29], v[200:203], v[152:155]
    v_mfma_f32_16x16x32_bf16 v[156:159], v[24:27], v[200:203], v[156:159]
    v_mfma_f32_16x16x32_bf16 v[160:163], v[26:29], v[204:207], v[160:163]
    v_mfma_f32_16x16x32_bf16 v[164:167], v[24:27], v[204:207], v[164:167]
    v_mfma_f32_16x16x32_bf16 v[168:171], v[26:29], v[208:211], v[168:171]
    v_mfma_f32_16x16x32_bf16 v[172:175], v[24:27], v[208:211], v[172:175]
    v_mfma_f32_16x16x32_bf16 v[176:179], v[26:29], v[212:215], v[176:179]
    v_mfma_f32_16x16x32_bf16 v[180:183], v[24:27], v[212:215], v[180:183]
L_quip_kernela2_done:
    s_nop 7
    s_nop 1
    s_waitcnt vmcnt(0)
    v_cvt_pk_bf16_f32 v72, v120, v121
    v_cvt_pk_bf16_f32 v73, v122, v123
    v_cvt_pk_bf16_f32 v74, v136, v137
    v_cvt_pk_bf16_f32 v75, v138, v139
    buffer_store_dwordx4 v[72:75], v12, s[32:35], s60 offen offset:0 sc1
    ds_write_b128 v9, v[72:75] offset:0
    v_cvt_pk_bf16_f32 v76, v124, v125
    v_cvt_pk_bf16_f32 v77, v126, v127
    v_cvt_pk_bf16_f32 v78, v140, v141
    v_cvt_pk_bf16_f32 v79, v142, v143
    buffer_store_dwordx4 v[76:79], v12, s[32:35], s60 offen offset:128 sc1
    ds_write_b128 v9, v[76:79] offset:128
    v_cvt_pk_bf16_f32 v80, v128, v129
    v_cvt_pk_bf16_f32 v81, v130, v131
    v_cvt_pk_bf16_f32 v82, v144, v145
    v_cvt_pk_bf16_f32 v83, v146, v147
    buffer_store_dwordx4 v[80:83], v12, s[32:35], s60 offen offset:2048 sc1
    ds_write_b128 v9, v[80:83] offset:2048
    v_cvt_pk_bf16_f32 v84, v132, v133
    v_cvt_pk_bf16_f32 v85, v134, v135
    v_cvt_pk_bf16_f32 v86, v148, v149
    v_cvt_pk_bf16_f32 v87, v150, v151
    buffer_store_dwordx4 v[84:87], v12, s[32:35], s60 offen offset:2176 sc1
    ds_write_b128 v9, v[84:87] offset:2176
    v_cvt_pk_bf16_f32 v88, v152, v153
    v_cvt_pk_bf16_f32 v89, v154, v155
    v_cvt_pk_bf16_f32 v90, v168, v169
    v_cvt_pk_bf16_f32 v91, v170, v171
    buffer_store_dwordx4 v[88:91], v12, s[32:35], s61 offen offset:0 sc1
    ds_write_b128 v9, v[88:91] offset:8192
    v_cvt_pk_bf16_f32 v92, v156, v157
    v_cvt_pk_bf16_f32 v93, v158, v159
    v_cvt_pk_bf16_f32 v94, v172, v173
    v_cvt_pk_bf16_f32 v95, v174, v175
    buffer_store_dwordx4 v[92:95], v12, s[32:35], s61 offen offset:128 sc1
    ds_write_b128 v9, v[92:95] offset:8320
    v_cvt_pk_bf16_f32 v96, v160, v161
    v_cvt_pk_bf16_f32 v97, v162, v163
    v_cvt_pk_bf16_f32 v98, v176, v177
    v_cvt_pk_bf16_f32 v99, v178, v179
    buffer_store_dwordx4 v[96:99], v12, s[32:35], s61 offen offset:2048 sc1
    ds_write_b128 v9, v[96:99] offset:10240
    v_cvt_pk_bf16_f32 v100, v164, v165
    v_cvt_pk_bf16_f32 v101, v166, v167
    v_cvt_pk_bf16_f32 v102, v180, v181
    v_cvt_pk_bf16_f32 v103, v182, v183
    buffer_store_dwordx4 v[100:103], v12, s[32:35], s61 offen offset:2176 sc1
    ds_write_b128 v9, v[100:103] offset:10368
    s_waitcnt lgkmcnt(0)
    s_mov_b32 s52, s40
    s_mov_b32 s40, s41
    s_mov_b32 s41, s52
    s_mov_b32 s36, s16
    s_mov_b32 s37, s17
    s_mov_b32 s38, 14680064
    s_mov_b32 s39, 0x20000
    s_mul_i32 s52, s43, 8192
    s_add_u32 s52, s52, 131072
    v_mul_u32_u24 v12, 144, v3
    v_lshl_add_u32 v12, v4, 4, v12
    v_add_u32 v12, s52, v12
    v_lshrrev_b32 v6, 3, v2
    v_and_b32 v7, 7, v2
    v_mul_u32_u24 v13, 144, v6
    v_lshl_add_u32 v13, v7, 4, v13
    v_add_u32 v13, s52, v13
    v_mul_u32_u24 v14, 7168, v6
    v_lshl_add_u32 v14, v7, 4, v14
    s_lshl_b32 s52, s41, 1
    s_add_u32 s52, s52, s45
    s_mul_i32 s60, s52, 917504
    s_lshl_b32 s53, s40, 1
    s_add_u32 s53, s53, s44
    s_lshl_b32 s53, s53, 7
    s_add_u32 s60, s60, s53
    s_mul_i32 s52, s44, 4096
    s_add_u32 s52, s52, 0
    v_lshl_add_u32 v16, v2, 4, s52
    s_mul_i32 s52, s45, 8192
    s_add_u32 s52, s52, 65536
    v_lshl_add_u32 v17, v2, 4, s52
    v_add_u32 v18, 65536, v17
    s_mov_b32 s57, 0
    s_mov_b32 s58, 0
    s_barrier
    ds_read_b128 v[20:23], v16 offset:16384
    ds_read_b128 v[24:27], v16 offset:17408
    ds_read_b128 v[28:31], v16 offset:18432
    ds_read_b128 v[32:35], v16 offset:19456
    ds_read_b128 v[36:39], v17 offset:32768
    ds_read_b128 v[40:43], v17 offset:33792
    ds_read_b128 v[44:47], v17 offset:34816
    ds_read_b128 v[48:51], v17 offset:35840
    ds_read_b128 v[52:55], v17 offset:36864
    ds_read_b128 v[56:59], v17 offset:37888
    ds_read_b128 v[60:63], v17 offset:38912
    ds_read_b128 v[64:67], v17 offset:39936
    s_waitcnt lgkmcnt(0)
    v_mfma_f32_16x16x32_bf16 v[116:119], v[20:23], v[36:39], 0
    ds_read_b128 v[68:71], v16 offset:24576
    v_mfma_f32_16x16x32_bf16 v[148:151], v[24:27], v[36:39], 0
    ds_read_b128 v[72:75], v16 offset:25600
    v_mfma_f32_16x16x32_bf16 v[152:155], v[24:27], v[40:43], 0
    ds_read_b128 v[76:79], v16 offset:26624
    v_mfma_f32_16x16x32_bf16 v[120:123], v[20:23], v[40:43], 0
    ds_read_b128 v[80:83], v16 offset:27648
    v_mfma_f32_16x16x32_bf16 v[124:127], v[20:23], v[44:47], 0
    ds_read_b128 v[84:87], v17 offset:49152
    v_mfma_f32_16x16x32_bf16 v[156:159], v[24:27], v[44:47], 0
    ds_read_b128 v[88:91], v17 offset:50176
    v_mfma_f32_16x16x32_bf16 v[160:163], v[24:27], v[48:51], 0
    ds_read_b128 v[92:95], v17 offset:51200
    v_mfma_f32_16x16x32_bf16 v[128:131], v[20:23], v[48:51], 0
    ds_read_b128 v[96:99], v17 offset:52224
    v_mfma_f32_16x16x32_bf16 v[132:135], v[20:23], v[52:55], 0
    ds_read_b128 v[100:103], v17 offset:53248
    v_mfma_f32_16x16x32_bf16 v[164:167], v[24:27], v[52:55], 0
    ds_read_b128 v[104:107], v17 offset:54272
    v_mfma_f32_16x16x32_bf16 v[168:171], v[24:27], v[56:59], 0
    ds_read_b128 v[108:111], v17 offset:55296
    v_mfma_f32_16x16x32_bf16 v[136:139], v[20:23], v[56:59], 0
    ds_read_b128 v[112:115], v17 offset:56320
    v_mfma_f32_16x16x32_bf16 v[140:143], v[20:23], v[60:63], 0
    s_mov_b32 s57, 1
    s_cmp_eq_u32 s57, 1
    v_mfma_f32_16x16x32_bf16 v[172:175], v[24:27], v[60:63], 0
    v_mfma_f32_16x16x32_bf16 v[176:179], v[24:27], v[64:67], 0
    v_mfma_f32_16x16x32_bf16 v[144:147], v[20:23], v[64:67], 0
    v_mfma_f32_16x16x32_bf16 v[208:211], v[28:31], v[64:67], 0
    v_mfma_f32_16x16x32_bf16 v[240:243], v[32:35], v[64:67], 0
    v_mfma_f32_16x16x32_bf16 v[236:239], v[32:35], v[60:63], 0
    v_mfma_f32_16x16x32_bf16 v[204:207], v[28:31], v[60:63], 0
    v_mfma_f32_16x16x32_bf16 v[200:203], v[28:31], v[56:59], 0
    v_mfma_f32_16x16x32_bf16 v[232:235], v[32:35], v[56:59], 0
    v_mfma_f32_16x16x32_bf16 v[228:231], v[32:35], v[52:55], 0
    v_mfma_f32_16x16x32_bf16 v[196:199], v[28:31], v[52:55], 0
    v_mfma_f32_16x16x32_bf16 v[192:195], v[28:31], v[48:51], 0
    v_mfma_f32_16x16x32_bf16 v[224:227], v[32:35], v[48:51], 0
    v_mfma_f32_16x16x32_bf16 v[220:223], v[32:35], v[44:47], 0
    v_mfma_f32_16x16x32_bf16 v[188:191], v[28:31], v[44:47], 0
    v_mfma_f32_16x16x32_bf16 v[184:187], v[28:31], v[40:43], 0
    v_mfma_f32_16x16x32_bf16 v[216:219], v[32:35], v[40:43], 0
    v_mfma_f32_16x16x32_bf16 v[212:215], v[32:35], v[36:39], 0
    v_mfma_f32_16x16x32_bf16 v[180:183], v[28:31], v[36:39], 0
    s_waitcnt vmcnt(0)
    s_barrier
    s_cmp_eq_u32 s43, 0
    s_cbranch_scc0 L_pfa
    v_mov_b32 v10, 0
    v_mov_b32 v11, s65
    s_mov_b64 exec, 1
    buffer_store_dword v11, v10, s[32:35], s70 offen sc1
    s_mov_b64 exec, -1
L_pfa:
    s_cmp_eq_u32 s57, 1
    s_branch L_quip_kernelb_m0
.p2align 6
L_quip_kernelb_c0:
    s_waitcnt lgkmcnt(0)
    v_mfma_f32_16x16x32_bf16 v[116:119], v[20:23], v[36:39], v[116:119]
    ds_read_b128 v[68:71], v16 offset:24576
    v_mfma_f32_16x16x32_bf16 v[148:151], v[24:27], v[36:39], v[148:151]
    ds_read_b128 v[72:75], v16 offset:25600
    v_mfma_f32_16x16x32_bf16 v[152:155], v[24:27], v[40:43], v[152:155]
    ds_read_b128 v[76:79], v16 offset:26624
    v_mfma_f32_16x16x32_bf16 v[120:123], v[20:23], v[40:43], v[120:123]
    ds_read_b128 v[80:83], v16 offset:27648
    v_mfma_f32_16x16x32_bf16 v[124:127], v[20:23], v[44:47], v[124:127]
    ds_read_b128 v[84:87], v17 offset:49152
    v_mfma_f32_16x16x32_bf16 v[156:159], v[24:27], v[44:47], v[156:159]
    ds_read_b128 v[88:91], v17 offset:50176
    v_mfma_f32_16x16x32_bf16 v[160:163], v[24:27], v[48:51], v[160:163]
    ds_read_b128 v[92:95], v17 offset:51200
    v_mfma_f32_16x16x32_bf16 v[128:131], v[20:23], v[48:51], v[128:131]
    ds_read_b128 v[96:99], v17 offset:52224
    v_mfma_f32_16x16x32_bf16 v[132:135], v[20:23], v[52:55], v[132:135]
    ds_read_b128 v[100:103], v17 offset:53248
    v_mfma_f32_16x16x32_bf16 v[164:167], v[24:27], v[52:55], v[164:167]
    ds_read_b128 v[104:107], v17 offset:54272
    v_mfma_f32_16x16x32_bf16 v[168:171], v[24:27], v[56:59], v[168:171]
    ds_read_b128 v[108:111], v17 offset:55296
    v_mfma_f32_16x16x32_bf16 v[136:139], v[20:23], v[56:59], v[136:139]
    ds_read_b128 v[112:115], v17 offset:56320
    v_mfma_f32_16x16x32_bf16 v[140:143], v[20:23], v[60:63], v[140:143]
    s_add_u32 s57, s57, 1
    s_cmp_lt_u32 s57, 14
    v_mfma_f32_16x16x32_bf16 v[172:175], v[24:27], v[60:63], v[172:175]
    v_mfma_f32_16x16x32_bf16 v[176:179], v[24:27], v[64:67], v[176:179]
    v_mfma_f32_16x16x32_bf16 v[144:147], v[20:23], v[64:67], v[144:147]
    v_mfma_f32_16x16x32_bf16 v[208:211], v[28:31], v[64:67], v[208:211]
    v_mfma_f32_16x16x32_bf16 v[240:243], v[32:35], v[64:67], v[240:243]
    v_mfma_f32_16x16x32_bf16 v[236:239], v[32:35], v[60:63], v[236:239]
    v_mfma_f32_16x16x32_bf16 v[204:207], v[28:31], v[60:63], v[204:207]
    v_mfma_f32_16x16x32_bf16 v[200:203], v[28:31], v[56:59], v[200:203]
    v_mfma_f32_16x16x32_bf16 v[232:235], v[32:35], v[56:59], v[232:235]
    v_mfma_f32_16x16x32_bf16 v[228:231], v[32:35], v[52:55], v[228:231]
    v_mfma_f32_16x16x32_bf16 v[196:199], v[28:31], v[52:55], v[196:199]
    v_mfma_f32_16x16x32_bf16 v[192:195], v[28:31], v[48:51], v[192:195]
    v_mfma_f32_16x16x32_bf16 v[224:227], v[32:35], v[48:51], v[224:227]
    v_mfma_f32_16x16x32_bf16 v[220:223], v[32:35], v[44:47], v[220:223]
    v_mfma_f32_16x16x32_bf16 v[188:191], v[28:31], v[44:47], v[188:191]
    v_mfma_f32_16x16x32_bf16 v[184:187], v[28:31], v[40:43], v[184:187]
    v_mfma_f32_16x16x32_bf16 v[216:219], v[32:35], v[40:43], v[216:219]
    v_mfma_f32_16x16x32_bf16 v[212:215], v[32:35], v[36:39], v[212:215]
    v_mfma_f32_16x16x32_bf16 v[180:183], v[28:31], v[36:39], v[180:183]
L_quip_kernelb_m0:
    s_waitcnt lgkmcnt(0)
    s_barrier
    v_mfma_f32_16x16x32_bf16 v[116:119], v[68:71], v[84:87], v[116:119]
    ds_read_b128 v[20:23], v16 offset:32768
    v_mfma_f32_16x16x32_bf16 v[148:151], v[72:75], v[84:87], v[148:151]
    ds_read_b128 v[24:27], v16 offset:33792
    v_mfma_f32_16x16x32_bf16 v[152:155], v[72:75], v[88:91], v[152:155]
    ds_read_b128 v[28:31], v16 offset:34816
    v_mfma_f32_16x16x32_bf16 v[120:123], v[68:71], v[88:91], v[120:123]
    ds_read_b128 v[32:35], v16 offset:35840
    v_mfma_f32_16x16x32_bf16 v[124:127], v[68:71], v[92:95], v[124:127]
    ds_read_b128 v[36:39], v18 offset:0
    v_mfma_f32_16x16x32_bf16 v[156:159], v[72:75], v[92:95], v[156:159]
    ds_read_b128 v[40:43], v18 offset:1024
    v_mfma_f32_16x16x32_bf16 v[160:163], v[72:75], v[96:99], v[160:163]
    ds_read_b128 v[44:47], v18 offset:2048
    v_mfma_f32_16x16x32_bf16 v[128:131], v[68:71], v[96:99], v[128:131]
    ds_read_b128 v[48:51], v18 offset:3072
    v_mfma_f32_16x16x32_bf16 v[132:135], v[68:71], v[100:103], v[132:135]
    ds_read_b128 v[52:55], v18 offset:4096
    v_mfma_f32_16x16x32_bf16 v[164:167], v[72:75], v[100:103], v[164:167]
    ds_read_b128 v[56:59], v18 offset:5120
    v_mfma_f32_16x16x32_bf16 v[168:171], v[72:75], v[104:107], v[168:171]
    ds_read_b128 v[60:63], v18 offset:6144
    v_mfma_f32_16x16x32_bf16 v[136:139], v[68:71], v[104:107], v[136:139]
    ds_read_b128 v[64:67], v18 offset:7168
    v_mfma_f32_16x16x32_bf16 v[140:143], v[68:71], v[108:111], v[140:143]
    v_mfma_f32_16x16x32_bf16 v[172:175], v[72:75], v[108:111], v[172:175]
    v_mfma_f32_16x16x32_bf16 v[176:179], v[72:75], v[112:115], v[176:179]
    v_mfma_f32_16x16x32_bf16 v[144:147], v[68:71], v[112:115], v[144:147]
    v_mfma_f32_16x16x32_bf16 v[208:211], v[76:79], v[112:115], v[208:211]
    v_mfma_f32_16x16x32_bf16 v[240:243], v[80:83], v[112:115], v[240:243]
    v_mfma_f32_16x16x32_bf16 v[236:239], v[80:83], v[108:111], v[236:239]
    v_mfma_f32_16x16x32_bf16 v[204:207], v[76:79], v[108:111], v[204:207]
    v_mfma_f32_16x16x32_bf16 v[200:203], v[76:79], v[104:107], v[200:203]
    v_mfma_f32_16x16x32_bf16 v[232:235], v[80:83], v[104:107], v[232:235]
    v_mfma_f32_16x16x32_bf16 v[228:231], v[80:83], v[100:103], v[228:231]
    v_mfma_f32_16x16x32_bf16 v[196:199], v[76:79], v[100:103], v[196:199]
    v_mfma_f32_16x16x32_bf16 v[192:195], v[76:79], v[96:99], v[192:195]
    v_mfma_f32_16x16x32_bf16 v[224:227], v[80:83], v[96:99], v[224:227]
    v_mfma_f32_16x16x32_bf16 v[220:223], v[80:83], v[92:95], v[220:223]
    v_mfma_f32_16x16x32_bf16 v[188:191], v[76:79], v[92:95], v[188:191]
    v_mfma_f32_16x16x32_bf16 v[184:187], v[76:79], v[88:91], v[184:187]
    v_mfma_f32_16x16x32_bf16 v[216:219], v[80:83], v[88:91], v[216:219]
    v_mfma_f32_16x16x32_bf16 v[212:215], v[80:83], v[84:87], v[212:215]
    v_mfma_f32_16x16x32_bf16 v[180:183], v[76:79], v[84:87], v[180:183]
L_quip_kernelb_c1:
    s_waitcnt lgkmcnt(0)
    v_mfma_f32_16x16x32_bf16 v[116:119], v[20:23], v[36:39], v[116:119]
    ds_read_b128 v[68:71], v16 offset:40960
    v_mfma_f32_16x16x32_bf16 v[148:151], v[24:27], v[36:39], v[148:151]
    ds_read_b128 v[72:75], v16 offset:41984
    v_mfma_f32_16x16x32_bf16 v[152:155], v[24:27], v[40:43], v[152:155]
    ds_read_b128 v[76:79], v16 offset:43008
    v_mfma_f32_16x16x32_bf16 v[120:123], v[20:23], v[40:43], v[120:123]
    ds_read_b128 v[80:83], v16 offset:44032
    v_mfma_f32_16x16x32_bf16 v[124:127], v[20:23], v[44:47], v[124:127]
    ds_read_b128 v[84:87], v18 offset:16384
    v_mfma_f32_16x16x32_bf16 v[156:159], v[24:27], v[44:47], v[156:159]
    ds_read_b128 v[88:91], v18 offset:17408
    v_mfma_f32_16x16x32_bf16 v[160:163], v[24:27], v[48:51], v[160:163]
    ds_read_b128 v[92:95], v18 offset:18432
    v_mfma_f32_16x16x32_bf16 v[128:131], v[20:23], v[48:51], v[128:131]
    ds_read_b128 v[96:99], v18 offset:19456
    v_mfma_f32_16x16x32_bf16 v[132:135], v[20:23], v[52:55], v[132:135]
    ds_read_b128 v[100:103], v18 offset:20480
    v_mfma_f32_16x16x32_bf16 v[164:167], v[24:27], v[52:55], v[164:167]
    ds_read_b128 v[104:107], v18 offset:21504
    v_mfma_f32_16x16x32_bf16 v[168:171], v[24:27], v[56:59], v[168:171]
    ds_read_b128 v[108:111], v18 offset:22528
    v_mfma_f32_16x16x32_bf16 v[136:139], v[20:23], v[56:59], v[136:139]
    ds_read_b128 v[112:115], v18 offset:23552
    v_mfma_f32_16x16x32_bf16 v[140:143], v[20:23], v[60:63], v[140:143]
    s_add_u32 s57, s57, 1
    s_cmp_lt_u32 s57, 14
    v_mfma_f32_16x16x32_bf16 v[172:175], v[24:27], v[60:63], v[172:175]
    v_mfma_f32_16x16x32_bf16 v[176:179], v[24:27], v[64:67], v[176:179]
    v_mfma_f32_16x16x32_bf16 v[144:147], v[20:23], v[64:67], v[144:147]
    v_mfma_f32_16x16x32_bf16 v[208:211], v[28:31], v[64:67], v[208:211]
    v_mfma_f32_16x16x32_bf16 v[240:243], v[32:35], v[64:67], v[240:243]
    v_mfma_f32_16x16x32_bf16 v[236:239], v[32:35], v[60:63], v[236:239]
    v_mfma_f32_16x16x32_bf16 v[204:207], v[28:31], v[60:63], v[204:207]
    v_mfma_f32_16x16x32_bf16 v[200:203], v[28:31], v[56:59], v[200:203]
    v_mfma_f32_16x16x32_bf16 v[232:235], v[32:35], v[56:59], v[232:235]
    v_mfma_f32_16x16x32_bf16 v[228:231], v[32:35], v[52:55], v[228:231]
    v_mfma_f32_16x16x32_bf16 v[196:199], v[28:31], v[52:55], v[196:199]
    v_mfma_f32_16x16x32_bf16 v[192:195], v[28:31], v[48:51], v[192:195]
    v_mfma_f32_16x16x32_bf16 v[224:227], v[32:35], v[48:51], v[224:227]
    v_mfma_f32_16x16x32_bf16 v[220:223], v[32:35], v[44:47], v[220:223]
    v_mfma_f32_16x16x32_bf16 v[188:191], v[28:31], v[44:47], v[188:191]
    v_mfma_f32_16x16x32_bf16 v[184:187], v[28:31], v[40:43], v[184:187]
    v_mfma_f32_16x16x32_bf16 v[216:219], v[32:35], v[40:43], v[216:219]
    v_mfma_f32_16x16x32_bf16 v[212:215], v[32:35], v[36:39], v[212:215]
    v_mfma_f32_16x16x32_bf16 v[180:183], v[28:31], v[36:39], v[180:183]
L_quip_kernelb_m1:
    s_waitcnt lgkmcnt(0)
    s_barrier
    s_cbranch_scc0 L_quip_kernelb_tail
    v_mfma_f32_16x16x32_bf16 v[116:119], v[68:71], v[84:87], v[116:119]
    ds_read_b128 v[20:23], v16 offset:0
    v_mfma_f32_16x16x32_bf16 v[148:151], v[72:75], v[84:87], v[148:151]
    ds_read_b128 v[24:27], v16 offset:1024
    v_mfma_f32_16x16x32_bf16 v[152:155], v[72:75], v[88:91], v[152:155]
    ds_read_b128 v[28:31], v16 offset:2048
    v_mfma_f32_16x16x32_bf16 v[120:123], v[68:71], v[88:91], v[120:123]
    ds_read_b128 v[32:35], v16 offset:3072
    v_mfma_f32_16x16x32_bf16 v[124:127], v[68:71], v[92:95], v[124:127]
    ds_read_b128 v[36:39], v17 offset:0
    v_mfma_f32_16x16x32_bf16 v[156:159], v[72:75], v[92:95], v[156:159]
    ds_read_b128 v[40:43], v17 offset:1024
    v_mfma_f32_16x16x32_bf16 v[160:163], v[72:75], v[96:99], v[160:163]
    ds_read_b128 v[44:47], v17 offset:2048
    v_mfma_f32_16x16x32_bf16 v[128:131], v[68:71], v[96:99], v[128:131]
    ds_read_b128 v[48:51], v17 offset:3072
    v_mfma_f32_16x16x32_bf16 v[132:135], v[68:71], v[100:103], v[132:135]
    ds_read_b128 v[52:55], v17 offset:4096
    v_mfma_f32_16x16x32_bf16 v[164:167], v[72:75], v[100:103], v[164:167]
    ds_read_b128 v[56:59], v17 offset:5120
    v_mfma_f32_16x16x32_bf16 v[168:171], v[72:75], v[104:107], v[168:171]
    ds_read_b128 v[60:63], v17 offset:6144
    v_mfma_f32_16x16x32_bf16 v[136:139], v[68:71], v[104:107], v[136:139]
    ds_read_b128 v[64:67], v17 offset:7168
    v_mfma_f32_16x16x32_bf16 v[140:143], v[68:71], v[108:111], v[140:143]
    v_mfma_f32_16x16x32_bf16 v[172:175], v[72:75], v[108:111], v[172:175]
    v_mfma_f32_16x16x32_bf16 v[176:179], v[72:75], v[112:115], v[176:179]
    v_mfma_f32_16x16x32_bf16 v[144:147], v[68:71], v[112:115], v[144:147]
    v_mfma_f32_16x16x32_bf16 v[208:211], v[76:79], v[112:115], v[208:211]
    v_mfma_f32_16x16x32_bf16 v[240:243], v[80:83], v[112:115], v[240:243]
    v_mfma_f32_16x16x32_bf16 v[236:239], v[80:83], v[108:111], v[236:239]
    v_mfma_f32_16x16x32_bf16 v[204:207], v[76:79], v[108:111], v[204:207]
    v_mfma_f32_16x16x32_bf16 v[200:203], v[76:79], v[104:107], v[200:203]
    v_mfma_f32_16x16x32_bf16 v[232:235], v[80:83], v[104:107], v[232:235]
    v_mfma_f32_16x16x32_bf16 v[228:231], v[80:83], v[100:103], v[228:231]
    v_mfma_f32_16x16x32_bf16 v[196:199], v[76:79], v[100:103], v[196:199]
    v_mfma_f32_16x16x32_bf16 v[192:195], v[76:79], v[96:99], v[192:195]
    v_mfma_f32_16x16x32_bf16 v[224:227], v[80:83], v[96:99], v[224:227]
    v_mfma_f32_16x16x32_bf16 v[220:223], v[80:83], v[92:95], v[220:223]
    v_mfma_f32_16x16x32_bf16 v[188:191], v[76:79], v[92:95], v[188:191]
    v_mfma_f32_16x16x32_bf16 v[184:187], v[76:79], v[88:91], v[184:187]
    v_mfma_f32_16x16x32_bf16 v[216:219], v[80:83], v[88:91], v[216:219]
    v_mfma_f32_16x16x32_bf16 v[212:215], v[80:83], v[84:87], v[212:215]
    v_mfma_f32_16x16x32_bf16 v[180:183], v[76:79], v[84:87], v[180:183]
L_quip_kernelb_c2:
    s_waitcnt lgkmcnt(0)
    v_mfma_f32_16x16x32_bf16 v[116:119], v[20:23], v[36:39], v[116:119]
    ds_read_b128 v[68:71], v16 offset:8192
    v_mfma_f32_16x16x32_bf16 v[148:151], v[24:27], v[36:39], v[148:151]
    ds_read_b128 v[72:75], v16 offset:9216
    v_mfma_f32_16x16x32_bf16 v[152:155], v[24:27], v[40:43], v[152:155]
    ds_read_b128 v[76:79], v16 offset:10240
    v_mfma_f32_16x16x32_bf16 v[120:123], v[20:23], v[40:43], v[120:123]
    ds_read_b128 v[80:83], v16 offset:11264
    v_mfma_f32_16x16x32_bf16 v[124:127], v[20:23], v[44:47], v[124:127]
    ds_read_b128 v[84:87], v17 offset:16384
    v_mfma_f32_16x16x32_bf16 v[156:159], v[24:27], v[44:47], v[156:159]
    ds_read_b128 v[88:91], v17 offset:17408
    v_mfma_f32_16x16x32_bf16 v[160:163], v[24:27], v[48:51], v[160:163]
    ds_read_b128 v[92:95], v17 offset:18432
    v_mfma_f32_16x16x32_bf16 v[128:131], v[20:23], v[48:51], v[128:131]
    ds_read_b128 v[96:99], v17 offset:19456
    v_mfma_f32_16x16x32_bf16 v[132:135], v[20:23], v[52:55], v[132:135]
    ds_read_b128 v[100:103], v17 offset:20480
    v_mfma_f32_16x16x32_bf16 v[164:167], v[24:27], v[52:55], v[164:167]
    ds_read_b128 v[104:107], v17 offset:21504
    v_mfma_f32_16x16x32_bf16 v[168:171], v[24:27], v[56:59], v[168:171]
    ds_read_b128 v[108:111], v17 offset:22528
    v_mfma_f32_16x16x32_bf16 v[136:139], v[20:23], v[56:59], v[136:139]
    ds_read_b128 v[112:115], v17 offset:23552
    v_mfma_f32_16x16x32_bf16 v[140:143], v[20:23], v[60:63], v[140:143]
    s_add_u32 s57, s57, 1
    s_cmp_lt_u32 s57, 14
    v_mfma_f32_16x16x32_bf16 v[172:175], v[24:27], v[60:63], v[172:175]
    v_mfma_f32_16x16x32_bf16 v[176:179], v[24:27], v[64:67], v[176:179]
    v_mfma_f32_16x16x32_bf16 v[144:147], v[20:23], v[64:67], v[144:147]
    v_mfma_f32_16x16x32_bf16 v[208:211], v[28:31], v[64:67], v[208:211]
    v_mfma_f32_16x16x32_bf16 v[240:243], v[32:35], v[64:67], v[240:243]
    v_mfma_f32_16x16x32_bf16 v[236:239], v[32:35], v[60:63], v[236:239]
    v_mfma_f32_16x16x32_bf16 v[204:207], v[28:31], v[60:63], v[204:207]
    v_mfma_f32_16x16x32_bf16 v[200:203], v[28:31], v[56:59], v[200:203]
    v_mfma_f32_16x16x32_bf16 v[232:235], v[32:35], v[56:59], v[232:235]
    v_mfma_f32_16x16x32_bf16 v[228:231], v[32:35], v[52:55], v[228:231]
    v_mfma_f32_16x16x32_bf16 v[196:199], v[28:31], v[52:55], v[196:199]
    v_mfma_f32_16x16x32_bf16 v[192:195], v[28:31], v[48:51], v[192:195]
    v_mfma_f32_16x16x32_bf16 v[224:227], v[32:35], v[48:51], v[224:227]
    v_mfma_f32_16x16x32_bf16 v[220:223], v[32:35], v[44:47], v[220:223]
    v_mfma_f32_16x16x32_bf16 v[188:191], v[28:31], v[44:47], v[188:191]
    v_mfma_f32_16x16x32_bf16 v[184:187], v[28:31], v[40:43], v[184:187]
    v_mfma_f32_16x16x32_bf16 v[216:219], v[32:35], v[40:43], v[216:219]
    v_mfma_f32_16x16x32_bf16 v[212:215], v[32:35], v[36:39], v[212:215]
    v_mfma_f32_16x16x32_bf16 v[180:183], v[28:31], v[36:39], v[180:183]
L_quip_kernelb_m2:
    s_waitcnt lgkmcnt(0)
    s_barrier
    v_mfma_f32_16x16x32_bf16 v[116:119], v[68:71], v[84:87], v[116:119]
    ds_read_b128 v[20:23], v16 offset:16384
    v_mfma_f32_16x16x32_bf16 v[148:151], v[72:75], v[84:87], v[148:151]
    ds_read_b128 v[24:27], v16 offset:17408
    v_mfma_f32_16x16x32_bf16 v[152:155], v[72:75], v[88:91], v[152:155]
    ds_read_b128 v[28:31], v16 offset:18432
    v_mfma_f32_16x16x32_bf16 v[120:123], v[68:71], v[88:91], v[120:123]
    ds_read_b128 v[32:35], v16 offset:19456
    v_mfma_f32_16x16x32_bf16 v[124:127], v[68:71], v[92:95], v[124:127]
    ds_read_b128 v[36:39], v17 offset:32768
    v_mfma_f32_16x16x32_bf16 v[156:159], v[72:75], v[92:95], v[156:159]
    ds_read_b128 v[40:43], v17 offset:33792
    v_mfma_f32_16x16x32_bf16 v[160:163], v[72:75], v[96:99], v[160:163]
    ds_read_b128 v[44:47], v17 offset:34816
    v_mfma_f32_16x16x32_bf16 v[128:131], v[68:71], v[96:99], v[128:131]
    ds_read_b128 v[48:51], v17 offset:35840
    v_mfma_f32_16x16x32_bf16 v[132:135], v[68:71], v[100:103], v[132:135]
    ds_read_b128 v[52:55], v17 offset:36864
    v_mfma_f32_16x16x32_bf16 v[164:167], v[72:75], v[100:103], v[164:167]
    ds_read_b128 v[56:59], v17 offset:37888
    v_mfma_f32_16x16x32_bf16 v[168:171], v[72:75], v[104:107], v[168:171]
    ds_read_b128 v[60:63], v17 offset:38912
    v_mfma_f32_16x16x32_bf16 v[136:139], v[68:71], v[104:107], v[136:139]
    ds_read_b128 v[64:67], v17 offset:39936
    v_mfma_f32_16x16x32_bf16 v[140:143], v[68:71], v[108:111], v[140:143]
    v_mfma_f32_16x16x32_bf16 v[172:175], v[72:75], v[108:111], v[172:175]
    v_mfma_f32_16x16x32_bf16 v[176:179], v[72:75], v[112:115], v[176:179]
    v_mfma_f32_16x16x32_bf16 v[144:147], v[68:71], v[112:115], v[144:147]
    v_mfma_f32_16x16x32_bf16 v[208:211], v[76:79], v[112:115], v[208:211]
    v_mfma_f32_16x16x32_bf16 v[240:243], v[80:83], v[112:115], v[240:243]
    v_mfma_f32_16x16x32_bf16 v[236:239], v[80:83], v[108:111], v[236:239]
    v_mfma_f32_16x16x32_bf16 v[204:207], v[76:79], v[108:111], v[204:207]
    v_mfma_f32_16x16x32_bf16 v[200:203], v[76:79], v[104:107], v[200:203]
    v_mfma_f32_16x16x32_bf16 v[232:235], v[80:83], v[104:107], v[232:235]
    v_mfma_f32_16x16x32_bf16 v[228:231], v[80:83], v[100:103], v[228:231]
    v_mfma_f32_16x16x32_bf16 v[196:199], v[76:79], v[100:103], v[196:199]
    v_mfma_f32_16x16x32_bf16 v[192:195], v[76:79], v[96:99], v[192:195]
    v_mfma_f32_16x16x32_bf16 v[224:227], v[80:83], v[96:99], v[224:227]
    v_mfma_f32_16x16x32_bf16 v[220:223], v[80:83], v[92:95], v[220:223]
    v_mfma_f32_16x16x32_bf16 v[188:191], v[76:79], v[92:95], v[188:191]
    v_mfma_f32_16x16x32_bf16 v[184:187], v[76:79], v[88:91], v[184:187]
    v_mfma_f32_16x16x32_bf16 v[216:219], v[80:83], v[88:91], v[216:219]
    v_mfma_f32_16x16x32_bf16 v[212:215], v[80:83], v[84:87], v[212:215]
    v_mfma_f32_16x16x32_bf16 v[180:183], v[76:79], v[84:87], v[180:183]
    s_branch L_quip_kernelb_c0
L_quip_kernelb_tail:
    v_mfma_f32_16x16x32_bf16 v[116:119], v[68:71], v[84:87], v[116:119]
    ds_read_b128 v[20:23], v16 offset:0
    v_mfma_f32_16x16x32_bf16 v[148:151], v[72:75], v[84:87], v[148:151]
    ds_read_b128 v[24:27], v16 offset:1024
    v_mfma_f32_16x16x32_bf16 v[152:155], v[72:75], v[88:91], v[152:155]
    ds_read_b128 v[28:31], v16 offset:2048
    v_mfma_f32_16x16x32_bf16 v[120:123], v[68:71], v[88:91], v[120:123]
    ds_read_b128 v[32:35], v16 offset:3072
    v_mfma_f32_16x16x32_bf16 v[124:127], v[68:71], v[92:95], v[124:127]
    ds_read_b128 v[52:55], v17 offset:0
    v_mfma_f32_16x16x32_bf16 v[156:159], v[72:75], v[92:95], v[156:159]
    ds_read_b128 v[56:59], v17 offset:16384
    v_mfma_f32_16x16x32_bf16 v[160:163], v[72:75], v[96:99], v[160:163]
    ds_read_b128 v[36:39], v16 offset:8192
    v_mfma_f32_16x16x32_bf16 v[128:131], v[68:71], v[96:99], v[128:131]
    ds_read_b128 v[40:43], v16 offset:9216
    v_mfma_f32_16x16x32_bf16 v[132:135], v[68:71], v[100:103], v[132:135]
    ds_read_b128 v[44:47], v16 offset:10240
    v_mfma_f32_16x16x32_bf16 v[164:167], v[72:75], v[100:103], v[164:167]
    ds_read_b128 v[48:51], v16 offset:11264
    v_mfma_f32_16x16x32_bf16 v[168:171], v[72:75], v[104:107], v[168:171]
    v_mfma_f32_16x16x32_bf16 v[136:139], v[68:71], v[104:107], v[136:139]
    v_mfma_f32_16x16x32_bf16 v[140:143], v[68:71], v[108:111], v[140:143]
    v_mfma_f32_16x16x32_bf16 v[172:175], v[72:75], v[108:111], v[172:175]
    v_mfma_f32_16x16x32_bf16 v[176:179], v[72:75], v[112:115], v[176:179]
    v_mfma_f32_16x16x32_bf16 v[144:147], v[68:71], v[112:115], v[144:147]
    v_mfma_f32_16x16x32_bf16 v[208:211], v[76:79], v[112:115], v[208:211]
    v_mfma_f32_16x16x32_bf16 v[240:243], v[80:83], v[112:115], v[240:243]
    v_mfma_f32_16x16x32_bf16 v[236:239], v[80:83], v[108:111], v[236:239]
    v_mfma_f32_16x16x32_bf16 v[204:207], v[76:79], v[108:111], v[204:207]
    v_mfma_f32_16x16x32_bf16 v[200:203], v[76:79], v[104:107], v[200:203]
    v_mfma_f32_16x16x32_bf16 v[232:235], v[80:83], v[104:107], v[232:235]
    v_mfma_f32_16x16x32_bf16 v[228:231], v[80:83], v[100:103], v[228:231]
    v_mfma_f32_16x16x32_bf16 v[196:199], v[76:79], v[100:103], v[196:199]
    v_mfma_f32_16x16x32_bf16 v[192:195], v[76:79], v[96:99], v[192:195]
    v_mfma_f32_16x16x32_bf16 v[224:227], v[80:83], v[96:99], v[224:227]
    v_mfma_f32_16x16x32_bf16 v[220:223], v[80:83], v[92:95], v[220:223]
    v_mfma_f32_16x16x32_bf16 v[188:191], v[76:79], v[92:95], v[188:191]
    v_mfma_f32_16x16x32_bf16 v[184:187], v[76:79], v[88:91], v[184:187]
    v_mfma_f32_16x16x32_bf16 v[216:219], v[80:83], v[88:91], v[216:219]
    v_mfma_f32_16x16x32_bf16 v[212:215], v[80:83], v[84:87], v[212:215]
    v_mfma_f32_16x16x32_bf16 v[180:183], v[76:79], v[84:87], v[180:183]
    s_waitcnt lgkmcnt(0)
    s_barrier
    ds_read_b128 v[68:71], v16 offset:16384
    ds_read_b128 v[72:75], v16 offset:17408
    v_mfma_f32_16x16x32_bf16 v[116:119], v[20:23], v[52:55], v[116:119]
    ds_read_b128 v[76:79], v16 offset:18432
    ds_read_b128 v[80:83], v16 offset:19456
    v_mfma_f32_16x16x32_bf16 v[148:151], v[24:27], v[52:55], v[148:151]
    ds_read_b128 v[60:63], v17 offset:32768
    ds_read_b128 v[84:87], v16 offset:24576
    v_mfma_f32_16x16x32_bf16 v[180:183], v[28:31], v[52:55], v[180:183]
    ds_read_b128 v[88:91], v16 offset:25600
    ds_read_b128 v[92:95], v16 offset:26624
    v_mfma_f32_16x16x32_bf16 v[212:215], v[32:35], v[52:55], v[212:215]
    ds_read_b128 v[96:99], v16 offset:27648
    ds_read_b128 v[64:67], v17 offset:49152
    v_mfma_f32_16x16x32_bf16 v[212:215], v[48:51], v[56:59], v[212:215]
    ds_read_b128 v[100:103], v17 offset:1024
    v_mfma_f32_16x16x32_bf16 v[180:183], v[44:47], v[56:59], v[180:183]
    ds_read_b128 v[104:107], v17 offset:17408
    v_mfma_f32_16x16x32_bf16 v[148:151], v[40:43], v[56:59], v[148:151]
    ds_read_b128 v[108:111], v17 offset:33792
    v_mfma_f32_16x16x32_bf16 v[116:119], v[36:39], v[56:59], v[116:119]
    ds_read_b128 v[112:115], v17 offset:50176
    s_waitcnt lgkmcnt(4)
    v_mfma_f32_16x16x32_bf16 v[116:119], v[68:71], v[60:63], v[116:119]
    v_mfma_f32_16x16x32_bf16 v[148:151], v[72:75], v[60:63], v[148:151]
    v_mfma_f32_16x16x32_bf16 v[180:183], v[76:79], v[60:63], v[180:183]
    v_mfma_f32_16x16x32_bf16 v[212:215], v[80:83], v[60:63], v[212:215]
    v_mfma_f32_16x16x32_bf16 v[212:215], v[96:99], v[64:67], v[212:215]
    v_mfma_f32_16x16x32_bf16 v[180:183], v[92:95], v[64:67], v[180:183]
    v_mfma_f32_16x16x32_bf16 v[148:151], v[88:91], v[64:67], v[148:151]
    v_mfma_f32_16x16x32_bf16 v[116:119], v[84:87], v[64:67], v[116:119]
    s_waitcnt lgkmcnt(0)
    v_mfma_f32_16x16x32_bf16 v[120:123], v[20:23], v[100:103], v[120:123]
    ds_read_b128 v[52:55], v17 offset:2048
    v_mfma_f32_16x16x32_bf16 v[152:155], v[24:27], v[100:103], v[152:155]
    ds_read_b128 v[56:59], v17 offset:18432
    v_mfma_f32_16x16x32_bf16 v[184:187], v[28:31], v[100:103], v[184:187]
    ds_read_b128 v[60:63], v17 offset:34816
    v_mfma_f32_16x16x32_bf16 v[216:219], v[32:35], v[100:103], v[216:219]
    ds_read_b128 v[64:67], v17 offset:51200
    v_mfma_f32_16x16x32_bf16 v[216:219], v[48:51], v[104:107], v[216:219]
    v_mfma_f32_16x16x32_bf16 v[184:187], v[44:47], v[104:107], v[184:187]
    v_mfma_f32_16x16x32_bf16 v[152:155], v[40:43], v[104:107], v[152:155]
    v_cvt_pk_bf16_f32 v180, v180, v181
    v_cvt_pk_bf16_f32 v181, v182, v183
    v_mfma_f32_16x16x32_bf16 v[120:123], v[36:39], v[104:107], v[120:123]
    v_cvt_pk_bf16_f32 v182, v212, v213
    v_cvt_pk_bf16_f32 v183, v214, v215
    v_mfma_f32_16x16x32_bf16 v[120:123], v[68:71], v[108:111], v[120:123]
    ds_write_b128 v12, v[180:183] offset:64
    v_mfma_f32_16x16x32_bf16 v[152:155], v[72:75], v[108:111], v[152:155]
    v_cvt_pk_bf16_f32 v116, v116, v117
    v_cvt_pk_bf16_f32 v117, v118, v119
    v_mfma_f32_16x16x32_bf16 v[184:187], v[76:79], v[108:111], v[184:187]
    v_cvt_pk_bf16_f32 v118, v148, v149
    v_cvt_pk_bf16_f32 v119, v150, v151
    v_mfma_f32_16x16x32_bf16 v[216:219], v[80:83], v[108:111], v[216:219]
    ds_write_b128 v12, v[116:119] offset:0
    v_mfma_f32_16x16x32_bf16 v[216:219], v[96:99], v[112:115], v[216:219]
    ds_read_b128 v[148:151], v13 offset:0
    v_mfma_f32_16x16x32_bf16 v[184:187], v[92:95], v[112:115], v[184:187]
    ds_read_b128 v[212:215], v13 offset:1152
    v_mfma_f32_16x16x32_bf16 v[152:155], v[88:91], v[112:115], v[152:155]
    v_mfma_f32_16x16x32_bf16 v[120:123], v[84:87], v[112:115], v[120:123]
    s_waitcnt lgkmcnt(4)
    v_mfma_f32_16x16x32_bf16 v[124:127], v[20:23], v[52:55], v[124:127]
    ds_read_b128 v[100:103], v17 offset:3072
    v_mfma_f32_16x16x32_bf16 v[156:159], v[24:27], v[52:55], v[156:159]
    ds_read_b128 v[104:107], v17 offset:19456
    v_mfma_f32_16x16x32_bf16 v[188:191], v[28:31], v[52:55], v[188:191]
    ds_read_b128 v[108:111], v17 offset:35840
    v_mfma_f32_16x16x32_bf16 v[220:223], v[32:35], v[52:55], v[220:223]
    ds_read_b128 v[112:115], v17 offset:52224
    v_mfma_f32_16x16x32_bf16 v[220:223], v[48:51], v[56:59], v[220:223]
    s_waitcnt lgkmcnt(4)
    buffer_store_dwordx4 v[148:151], v14, s[36:39], s60 offen nt
    s_add_u32 s60, s60, 57344
    v_mfma_f32_16x16x32_bf16 v[188:191], v[44:47], v[56:59], v[188:191]
    buffer_store_dwordx4 v[212:215], v14, s[36:39], s60 offen nt
    s_add_u32 s60, s60, 57344
    v_mfma_f32_16x16x32_bf16 v[156:159], v[40:43], v[56:59], v[156:159]
    v_cvt_pk_bf16_f32 v184, v184, v185
    v_cvt_pk_bf16_f32 v185, v186, v187
    v_mfma_f32_16x16x32_bf16 v[124:127], v[36:39], v[56:59], v[124:127]
    v_cvt_pk_bf16_f32 v186, v216, v217
    v_cvt_pk_bf16_f32 v187, v218, v219
    v_mfma_f32_16x16x32_bf16 v[124:127], v[68:71], v[60:63], v[124:127]
    ds_write_b128 v12, v[184:187] offset:2368
    v_mfma_f32_16x16x32_bf16 v[156:159], v[72:75], v[60:63], v[156:159]
    v_cvt_pk_bf16_f32 v120, v120, v121
    v_cvt_pk_bf16_f32 v121, v122, v123
    v_mfma_f32_16x16x32_bf16 v[188:191], v[76:79], v[60:63], v[188:191]
    v_cvt_pk_bf16_f32 v122, v152, v153
    v_cvt_pk_bf16_f32 v123, v154, v155
    v_mfma_f32_16x16x32_bf16 v[220:223], v[80:83], v[60:63], v[220:223]
    ds_write_b128 v12, v[120:123] offset:2304
    v_mfma_f32_16x16x32_bf16 v[220:223], v[96:99], v[64:67], v[220:223]
    ds_read_b128 v[152:155], v13 offset:2304
    v_mfma_f32_16x16x32_bf16 v[188:191], v[92:95], v[64:67], v[188:191]
    ds_read_b128 v[216:219], v13 offset:3456
    v_mfma_f32_16x16x32_bf16 v[156:159], v[88:91], v[64:67], v[156:159]
    v_mfma_f32_16x16x32_bf16 v[124:127], v[84:87], v[64:67], v[124:127]
    s_waitcnt lgkmcnt(4)
    v_mfma_f32_16x16x32_bf16 v[128:131], v[20:23], v[100:103], v[128:131]
    ds_read_b128 v[52:55], v17 offset:4096
    v_mfma_f32_16x16x32_bf16 v[160:163], v[24:27], v[100:103], v[160:163]
    ds_read_b128 v[56:59], v17 offset:20480
    v_mfma_f32_16x16x32_bf16 v[192:195], v[28:31], v[100:103], v[192:195]
    ds_read_b128 v[60:63], v17 offset:36864
    v_mfma_f32_16x16x32_bf16 v[224:227], v[32:35], v[100:103], v[224:227]
    ds_read_b128 v[64:67], v17 offset:53248
    v_mfma_f32_16x16x32_bf16 v[224:227], v[48:51], v[104:107], v[224:227]
    s_waitcnt lgkmcnt(4)
    buffer_store_dwordx4 v[152:155], v14, s[36:39], s60 offen nt
    s_add_u32 s60, s60, 57344
    v_mfma_f32_16x16x32_bf16 v[192:195], v[44:47], v[104:107], v[192:195]
    buffer_store_dwordx4 v[216:219], v14, s[36:39], s60 offen nt
    s_add_u32 s60, s60, 57344
    v_mfma_f32_16x16x32_bf16 v[160:163], v[40:43], v[104:107], v[160:163]
    v_cvt_pk_bf16_f32 v188, v188, v189
    v_cvt_pk_bf16_f32 v189, v190, v191
    v_mfma_f32_16x16x32_bf16 v[128:131], v[36:39], v[104:107], v[128:131]
    v_cvt_pk_bf16_f32 v190, v220, v221
    v_cvt_pk_bf16_f32 v191, v222, v223
    v_mfma_f32_16x16x32_bf16 v[128:131], v[68:71], v[108:111], v[128:131]
    ds_write_b128 v12, v[188:191] offset:64
    v_mfma_f32_16x16x32_bf16 v[160:163], v[72:75], v[108:111], v[160:163]
    v_cvt_pk_bf16_f32 v124, v124, v125
    v_cvt_pk_bf16_f32 v125, v126, v127
    v_mfma_f32_16x16x32_bf16 v[192:195], v[76:79], v[108:111], v[192:195]
    v_cvt_pk_bf16_f32 v126, v156, v157
    v_cvt_pk_bf16_f32 v127, v158, v159
    v_mfma_f32_16x16x32_bf16 v[224:227], v[80:83], v[108:111], v[224:227]
    ds_write_b128 v12, v[124:127] offset:0
    v_mfma_f32_16x16x32_bf16 v[224:227], v[96:99], v[112:115], v[224:227]
    ds_read_b128 v[156:159], v13 offset:0
    v_mfma_f32_16x16x32_bf16 v[192:195], v[92:95], v[112:115], v[192:195]
    ds_read_b128 v[220:223], v13 offset:1152
    v_mfma_f32_16x16x32_bf16 v[160:163], v[88:91], v[112:115], v[160:163]
    v_mfma_f32_16x16x32_bf16 v[128:131], v[84:87], v[112:115], v[128:131]
    s_waitcnt lgkmcnt(4)
    v_mfma_f32_16x16x32_bf16 v[132:135], v[20:23], v[52:55], v[132:135]
    ds_read_b128 v[100:103], v17 offset:5120
    v_mfma_f32_16x16x32_bf16 v[164:167], v[24:27], v[52:55], v[164:167]
    ds_read_b128 v[104:107], v17 offset:21504
    v_mfma_f32_16x16x32_bf16 v[196:199], v[28:31], v[52:55], v[196:199]
    ds_read_b128 v[108:111], v17 offset:37888
    v_mfma_f32_16x16x32_bf16 v[228:231], v[32:35], v[52:55], v[228:231]
    ds_read_b128 v[112:115], v17 offset:54272
    v_mfma_f32_16x16x32_bf16 v[228:231], v[48:51], v[56:59], v[228:231]
    s_waitcnt lgkmcnt(4)
    buffer_store_dwordx4 v[156:159], v14, s[36:39], s60 offen nt
    s_add_u32 s60, s60, 57344
    v_mfma_f32_16x16x32_bf16 v[196:199], v[44:47], v[56:59], v[196:199]
    buffer_store_dwordx4 v[220:223], v14, s[36:39], s60 offen nt
    s_add_u32 s60, s60, 57344
    v_mfma_f32_16x16x32_bf16 v[164:167], v[40:43], v[56:59], v[164:167]
    v_cvt_pk_bf16_f32 v192, v192, v193
    v_cvt_pk_bf16_f32 v193, v194, v195
    v_mfma_f32_16x16x32_bf16 v[132:135], v[36:39], v[56:59], v[132:135]
    v_cvt_pk_bf16_f32 v194, v224, v225
    v_cvt_pk_bf16_f32 v195, v226, v227
    v_mfma_f32_16x16x32_bf16 v[132:135], v[68:71], v[60:63], v[132:135]
    ds_write_b128 v12, v[192:195] offset:2368
    v_mfma_f32_16x16x32_bf16 v[164:167], v[72:75], v[60:63], v[164:167]
    v_cvt_pk_bf16_f32 v128, v128, v129
    v_cvt_pk_bf16_f32 v129, v130, v131
    v_mfma_f32_16x16x32_bf16 v[196:199], v[76:79], v[60:63], v[196:199]
    v_cvt_pk_bf16_f32 v130, v160, v161
    v_cvt_pk_bf16_f32 v131, v162, v163
    v_mfma_f32_16x16x32_bf16 v[228:231], v[80:83], v[60:63], v[228:231]
    ds_write_b128 v12, v[128:131] offset:2304
    v_mfma_f32_16x16x32_bf16 v[228:231], v[96:99], v[64:67], v[228:231]
    ds_read_b128 v[160:163], v13 offset:2304
    v_mfma_f32_16x16x32_bf16 v[196:199], v[92:95], v[64:67], v[196:199]
    ds_read_b128 v[224:227], v13 offset:3456
    v_mfma_f32_16x16x32_bf16 v[164:167], v[88:91], v[64:67], v[164:167]
    v_mfma_f32_16x16x32_bf16 v[132:135], v[84:87], v[64:67], v[132:135]
    s_waitcnt lgkmcnt(4)
    v_mfma_f32_16x16x32_bf16 v[136:139], v[20:23], v[100:103], v[136:139]
    ds_read_b128 v[52:55], v17 offset:6144
    v_mfma_f32_16x16x32_bf16 v[168:171], v[24:27], v[100:103], v[168:171]
    ds_read_b128 v[56:59], v17 offset:22528
    v_mfma_f32_16x16x32_bf16 v[200:203], v[28:31], v[100:103], v[200:203]
    ds_read_b128 v[60:63], v17 offset:38912
    v_mfma_f32_16x16x32_bf16 v[232:235], v[32:35], v[100:103], v[232:235]
    ds_read_b128 v[64:67], v17 offset:55296
    v_mfma_f32_16x16x32_bf16 v[232:235], v[48:51], v[104:107], v[232:235]
    s_waitcnt lgkmcnt(4)
    buffer_store_dwordx4 v[160:163], v14, s[36:39], s60 offen nt
    s_add_u32 s60, s60, 57344
    v_mfma_f32_16x16x32_bf16 v[200:203], v[44:47], v[104:107], v[200:203]
    buffer_store_dwordx4 v[224:227], v14, s[36:39], s60 offen nt
    s_add_u32 s60, s60, 57344
    v_mfma_f32_16x16x32_bf16 v[168:171], v[40:43], v[104:107], v[168:171]
    v_cvt_pk_bf16_f32 v196, v196, v197
    v_cvt_pk_bf16_f32 v197, v198, v199
    v_mfma_f32_16x16x32_bf16 v[136:139], v[36:39], v[104:107], v[136:139]
    v_cvt_pk_bf16_f32 v198, v228, v229
    v_cvt_pk_bf16_f32 v199, v230, v231
    v_mfma_f32_16x16x32_bf16 v[136:139], v[68:71], v[108:111], v[136:139]
    ds_write_b128 v12, v[196:199] offset:64
    v_mfma_f32_16x16x32_bf16 v[168:171], v[72:75], v[108:111], v[168:171]
    v_cvt_pk_bf16_f32 v132, v132, v133
    v_cvt_pk_bf16_f32 v133, v134, v135
    v_mfma_f32_16x16x32_bf16 v[200:203], v[76:79], v[108:111], v[200:203]
    v_cvt_pk_bf16_f32 v134, v164, v165
    v_cvt_pk_bf16_f32 v135, v166, v167
    v_mfma_f32_16x16x32_bf16 v[232:235], v[80:83], v[108:111], v[232:235]
    ds_write_b128 v12, v[132:135] offset:0
    v_mfma_f32_16x16x32_bf16 v[232:235], v[96:99], v[112:115], v[232:235]
    ds_read_b128 v[164:167], v13 offset:0
    v_mfma_f32_16x16x32_bf16 v[200:203], v[92:95], v[112:115], v[200:203]
    ds_read_b128 v[228:231], v13 offset:1152
    v_mfma_f32_16x16x32_bf16 v[168:171], v[88:91], v[112:115], v[168:171]
    v_mfma_f32_16x16x32_bf16 v[136:139], v[84:87], v[112:115], v[136:139]
    s_waitcnt lgkmcnt(4)
    v_mfma_f32_16x16x32_bf16 v[140:143], v[20:23], v[52:55], v[140:143]
    ds_read_b128 v[100:103], v17 offset:7168
    v_mfma_f32_16x16x32_bf16 v[172:175], v[24:27], v[52:55], v[172:175]
    ds_read_b128 v[104:107], v17 offset:23552
    v_mfma_f32_16x16x32_bf16 v[204:207], v[28:31], v[52:55], v[204:207]
    ds_read_b128 v[108:111], v17 offset:39936
    v_mfma_f32_16x16x32_bf16 v[236:239], v[32:35], v[52:55], v[236:239]
    ds_read_b128 v[112:115], v17 offset:56320
    v_mfma_f32_16x16x32_bf16 v[236:239], v[48:51], v[56:59], v[236:239]
    s_waitcnt lgkmcnt(4)
    buffer_store_dwordx4 v[164:167], v14, s[36:39], s60 offen nt
    s_add_u32 s60, s60, 57344
    v_mfma_f32_16x16x32_bf16 v[204:207], v[44:47], v[56:59], v[204:207]
    buffer_store_dwordx4 v[228:231], v14, s[36:39], s60 offen nt
    s_add_u32 s60, s60, 57344
    v_mfma_f32_16x16x32_bf16 v[172:175], v[40:43], v[56:59], v[172:175]
    v_cvt_pk_bf16_f32 v200, v200, v201
    v_cvt_pk_bf16_f32 v201, v202, v203
    v_mfma_f32_16x16x32_bf16 v[140:143], v[36:39], v[56:59], v[140:143]
    v_cvt_pk_bf16_f32 v202, v232, v233
    v_cvt_pk_bf16_f32 v203, v234, v235
    v_mfma_f32_16x16x32_bf16 v[140:143], v[68:71], v[60:63], v[140:143]
    ds_write_b128 v12, v[200:203] offset:2368
    v_mfma_f32_16x16x32_bf16 v[172:175], v[72:75], v[60:63], v[172:175]
    v_cvt_pk_bf16_f32 v136, v136, v137
    v_cvt_pk_bf16_f32 v137, v138, v139
    v_mfma_f32_16x16x32_bf16 v[204:207], v[76:79], v[60:63], v[204:207]
    v_cvt_pk_bf16_f32 v138, v168, v169
    v_cvt_pk_bf16_f32 v139, v170, v171
    v_mfma_f32_16x16x32_bf16 v[236:239], v[80:83], v[60:63], v[236:239]
    ds_write_b128 v12, v[136:139] offset:2304
    v_mfma_f32_16x16x32_bf16 v[236:239], v[96:99], v[64:67], v[236:239]
    ds_read_b128 v[168:171], v13 offset:2304
    v_mfma_f32_16x16x32_bf16 v[204:207], v[92:95], v[64:67], v[204:207]
    ds_read_b128 v[232:235], v13 offset:3456
    v_mfma_f32_16x16x32_bf16 v[172:175], v[88:91], v[64:67], v[172:175]
    v_mfma_f32_16x16x32_bf16 v[140:143], v[84:87], v[64:67], v[140:143]
    s_waitcnt lgkmcnt(4)
    v_mfma_f32_16x16x32_bf16 v[144:147], v[20:23], v[100:103], v[144:147]
    v_mfma_f32_16x16x32_bf16 v[176:179], v[24:27], v[100:103], v[176:179]
    v_mfma_f32_16x16x32_bf16 v[208:211], v[28:31], v[100:103], v[208:211]
    v_mfma_f32_16x16x32_bf16 v[240:243], v[32:35], v[100:103], v[240:243]
    v_mfma_f32_16x16x32_bf16 v[240:243], v[48:51], v[104:107], v[240:243]
    s_waitcnt lgkmcnt(0)
    buffer_store_dwordx4 v[168:171], v14, s[36:39], s60 offen nt
    s_add_u32 s60, s60, 57344
    v_mfma_f32_16x16x32_bf16 v[208:211], v[44:47], v[104:107], v[208:211]
    buffer_store_dwordx4 v[232:235], v14, s[36:39], s60 offen nt
    s_add_u32 s60, s60, 57344
    v_mfma_f32_16x16x32_bf16 v[176:179], v[40:43], v[104:107], v[176:179]
    v_cvt_pk_bf16_f32 v204, v204, v205
    v_cvt_pk_bf16_f32 v205, v206, v207
    v_mfma_f32_16x16x32_bf16 v[144:147], v[36:39], v[104:107], v[144:147]
    v_cvt_pk_bf16_f32 v206, v236, v237
    v_cvt_pk_bf16_f32 v207, v238, v239
    v_mfma_f32_16x16x32_bf16 v[144:147], v[68:71], v[108:111], v[144:147]
    ds_write_b128 v12, v[204:207] offset:64
    v_mfma_f32_16x16x32_bf16 v[176:179], v[72:75], v[108:111], v[176:179]
    v_cvt_pk_bf16_f32 v140, v140, v141
    v_cvt_pk_bf16_f32 v141, v142, v143
    v_mfma_f32_16x16x32_bf16 v[208:211], v[76:79], v[108:111], v[208:211]
    v_cvt_pk_bf16_f32 v142, v172, v173
    v_cvt_pk_bf16_f32 v143, v174, v175
    v_mfma_f32_16x16x32_bf16 v[240:243], v[80:83], v[108:111], v[240:243]
    ds_write_b128 v12, v[140:143] offset:0
    v_mfma_f32_16x16x32_bf16 v[240:243], v[96:99], v[112:115], v[240:243]
    ds_read_b128 v[172:175], v13 offset:0
    v_mfma_f32_16x16x32_bf16 v[208:211], v[92:95], v[112:115], v[208:211]
    ds_read_b128 v[236:239], v13 offset:1152
    v_mfma_f32_16x16x32_bf16 v[176:179], v[88:91], v[112:115], v[176:179]
    v_mfma_f32_16x16x32_bf16 v[144:147], v[84:87], v[112:115], v[144:147]
    s_waitcnt lgkmcnt(0)
    buffer_store_dwordx4 v[172:175], v14, s[36:39], s60 offen nt
    s_add_u32 s60, s60, 57344
    buffer_store_dwordx4 v[236:239], v14, s[36:39], s60 offen nt
    s_add_u32 s60, s60, 57344
    s_nop 3
    v_cvt_pk_bf16_f32 v208, v208, v209
    v_cvt_pk_bf16_f32 v209, v210, v211
    v_cvt_pk_bf16_f32 v210, v240, v241
    v_cvt_pk_bf16_f32 v211, v242, v243
    ds_write_b128 v12, v[208:211] offset:2368
    v_cvt_pk_bf16_f32 v144, v144, v145
    v_cvt_pk_bf16_f32 v145, v146, v147
    v_cvt_pk_bf16_f32 v146, v176, v177
    v_cvt_pk_bf16_f32 v147, v178, v179
    ds_write_b128 v12, v[144:147] offset:2304
    ds_read_b128 v[176:179], v13 offset:2304
    ds_read_b128 v[240:243], v13 offset:3456
    s_waitcnt lgkmcnt(0)
    buffer_store_dwordx4 v[176:179], v14, s[36:39], s60 offen nt
    s_add_u32 s60, s60, 57344
    buffer_store_dwordx4 v[240:243], v14, s[36:39], s60 offen nt
    s_add_u32 s60, s60, 57344
    s_endpgm
L_quip_kernel_A1:
    s_sub_u32 s42, s67, 28
    s_add_u32 s40, s42, s66
    s_and_b32 s40, s40, 7
    s_cmp_lt_u32 s40, 4
    s_cselect_b32 s69, 1, -1
    s_lshl_b32 s69, s69, 10
    s_mov_b32 s41, s66
    s_lshl_b32 s61, s66, 1
    s_cmp_lt_u32 s43, 4
    s_cbranch_scc1 L_quip_kernel_A1c
    s_setprio 3
    s_mov_b32 s24, s12
    s_mov_b32 s25, s13
    s_mov_b32 s26, 2097152
    s_mov_b32 s27, 0x20000
    s_mov_b32 s28, s4
    s_mov_b32 s29, s5
    s_mov_b32 s30, 4194304
    s_mov_b32 s31, 0x20000
    v_mul_u32_u24 v5, 2048, v4
    v_lshlrev_b32 v6, 1, v4
    v_xor_b32 v6, v6, v3
    v_lshl_add_u32 v7, v6, 4, v5
    v_xor_b32 v6, 8, v6
    v_lshl_add_u32 v8, v6, 4, v5
    v_add_u32 v16, 0, v7
    v_add_u32 v17, 7168, v7
    v_add_u32 v18, 14336, v8
    v_add_u32 v19, 21504, v8
    s_lshl_b32 s46, s40, 8
    s_mul_i32 s52, s59, 32768
    s_add_u32 s46, s46, s52
    v_lshrrev_b32 v5, 3, v2
    v_and_b32 v6, 7, v2
    v_lshrrev_b32 v7, 1, v5
    v_xor_b32 v6, v6, v7
    v_mul_u32_u24 v5, 2048, v5
    v_lshl_add_u32 v7, v6, 4, v5
    v_xor_b32 v6, 4, v6
    v_lshl_add_u32 v8, v6, 4, v5
    v_add_u32 v20, 0, v7
    v_add_u32 v21, 15360, v8
    v_add_u32 v22, 30720, v7
    v_add_u32 v23, 46080, v8
    s_mul_i32 s47, s41, 524288
    s_mul_i32 s52, s59, 131072
    s_add_u32 s47, s47, s52
    s_mul_i32 s50, s59, 4096
    s_add_u32 s50, s50, 0
    s_mul_i32 s51, s59, 8192
    s_add_u32 s51, s51, 49152
    s_add_u32 s57, s50, 49152
    s_add_u32 s58, s42, 12
    s_mov_b32 s54, 0
    s_mov_b32 s60, 0
    s_add_u32 s55, s50, 0
    s_add_u32 s56, s51, 0
    s_and_b32 s60, s54, 15
    s_sub_u32 s52, s60, 1
    s_and_b32 s53, s52, 3
    s_cmp_eq_u32 s53, s42
    s_cselect_b32 s53, 4, 0
    s_cmp_ge_u32 s52, s58
    s_cselect_b32 s53, 1, s53
    s_add_u32 s52, s52, s53
    s_cmp_eq_u32 s60, 0
    s_cselect_b32 s52, s42, s52
    s_add_u32 s52, s52, s61
    s_and_b32 s52, s52, 15
    s_mul_i32 s62, s52, 131072
    s_add_u32 s62, s62, s46
    s_mul_i32 s63, s52, 128
    s_add_u32 s63, s63, s47
    s_lshr_b32 s53, s54, 4
    s_mul_i32 s52, s53, s69
    s_add_u32 s62, s62, s52
    s_mov_b32 m0, s55
    s_mov_b32 s48, s62
    s_mov_b32 s49, s63
    buffer_load_dwordx4 v16, s[24:27], s48 offen offset:0  lds
    buffer_load_dwordx4 v17, s[24:27], s48 offen offset:1024  lds
    s_add_u32 s54, s54, 1
    s_and_b32 s60, s54, 15
    s_sub_u32 s52, s60, 1
    s_and_b32 s53, s52, 3
    s_cmp_eq_u32 s53, s42
    s_cselect_b32 s53, 4, 0
    s_cmp_ge_u32 s52, s58
    s_cselect_b32 s53, 1, s53
    s_add_u32 s52, s52, s53
    s_cmp_eq_u32 s60, 0
    s_cselect_b32 s52, s42, s52
    s_add_u32 s52, s52, s61
    s_and_b32 s52, s52, 15
    s_mul_i32 s62, s52, 131072
    s_add_u32 s62, s62, s46
    s_mul_i32 s63, s52, 128
    s_add_u32 s63, s63, s47
    s_lshr_b32 s53, s54, 4
    s_mul_i32 s52, s53, s69
    s_add_u32 s62, s62, s52
    buffer_load_dwordx4 v18, s[24:27], s48 offen offset:2048  lds
    buffer_load_dwordx4 v19, s[24:27], s48 offen offset:3072  lds
    s_mov_b32 m0, s56
    s_nop 0
    buffer_load_dwordx4 v20, s[28:31], s49 offen offset:0  lds
    s_add_u32 s55, s55, 16384
    s_add_u32 s56, s56, 32768
    s_cmp_eq_u32 s55, s57
    s_cselect_b32 s55, s50, s55
    s_cselect_b32 s56, s51, s56
    s_cmp_lt_u32 s54, 32
    s_cselect_b32 s64, 1, 0
    buffer_load_dwordx4 v21, s[28:31], s49 offen offset:1024  lds
    buffer_load_dwordx4 v22, s[28:31], s49 offen offset:2048  lds
    buffer_load_dwordx4 v23, s[28:31], s49 offen offset:3072  lds
    s_add_u32 m0, m0, 4096
    s_add_u32 s49, s49, 65536
    buffer_load_dwordx4 v20, s[28:31], s49 offen offset:0  lds
    buffer_load_dwordx4 v21, s[28:31], s49 offen offset:1024  lds
    buffer_load_dwordx4 v22, s[28:31], s49 offen offset:2048  lds
    buffer_load_dwordx4 v23, s[28:31], s49 offen offset:3072  lds
    s_mov_b32 m0, s55
    s_mov_b32 s48, s62
    s_mov_b32 s49, s63
    buffer_load_dwordx4 v16, s[24:27], s48 offen offset:0  lds
    buffer_load_dwordx4 v17, s[24:27], s48 offen offset:1024  lds
    s_add_u32 s54, s54, 1
    s_and_b32 s60, s54, 15
    s_sub_u32 s52, s60, 1
    s_and_b32 s53, s52, 3
    s_cmp_eq_u32 s53, s42
    s_cselect_b32 s53, 4, 0
    s_cmp_ge_u32 s52, s58
    s_cselect_b32 s53, 1, s53
    s_add_u32 s52, s52, s53
    s_cmp_eq_u32 s60, 0
    s_cselect_b32 s52, s42, s52
    s_add_u32 s52, s52, s61
    s_and_b32 s52, s52, 15
    s_mul_i32 s62, s52, 131072
    s_add_u32 s62, s62, s46
    s_mul_i32 s63, s52, 128
    s_add_u32 s63, s63, s47
    s_lshr_b32 s53, s54, 4
    s_mul_i32 s52, s53, s69
    s_add_u32 s62, s62, s52
    buffer_load_dwordx4 v18, s[24:27], s48 offen offset:2048  lds
    buffer_load_dwordx4 v19, s[24:27], s48 offen offset:3072  lds
    s_mov_b32 m0, s56
    s_nop 0
    buffer_load_dwordx4 v20, s[28:31], s49 offen offset:0  lds
    s_add_u32 s55, s55, 16384
    s_add_u32 s56, s56, 32768
    s_cmp_eq_u32 s55, s57
    s_cselect_b32 s55, s50, s55
    s_cselect_b32 s56, s51, s56
    s_cmp_lt_u32 s54, 32
    s_cselect_b32 s64, 1, 0
    buffer_load_dwordx4 v21, s[28:31], s49 offen offset:1024  lds
    buffer_load_dwordx4 v22, s[28:31], s49 offen offset:2048  lds
    buffer_load_dwordx4 v23, s[28:31], s49 offen offset:3072  lds
    s_add_u32 m0, m0, 4096
    s_add_u32 s49, s49, 65536
    buffer_load_dwordx4 v20, s[28:31], s49 offen offset:0  lds
    buffer_load_dwordx4 v21, s[28:31], s49 offen offset:1024  lds
    buffer_load_dwordx4 v22, s[28:31], s49 offen offset:2048  lds
    buffer_load_dwordx4 v23, s[28:31], s49 offen offset:3072  lds
    s_waitcnt vmcnt(12)
    s_barrier
.p2align 6
L_quip_kernela1_go:
    s_mov_b32 m0, s55
    s_mov_b32 s48, s62
    s_mov_b32 s49, s63
    buffer_load_dwordx4 v16, s[24:27], s48 offen offset:0  lds
    buffer_load_dwordx4 v17, s[24:27], s48 offen offset:1024  lds
    s_add_u32 s54, s54, 1
    s_and_b32 s60, s54, 15
    s_sub_u32 s52, s60, 1
    s_and_b32 s53, s52, 3
    s_cmp_eq_u32 s53, s42
    s_cselect_b32 s53, 4, 0
    s_cmp_ge_u32 s52, s58
    s_cselect_b32 s53, 1, s53
    s_add_u32 s52, s52, s53
    s_cmp_eq_u32 s60, 0
    s_cselect_b32 s52, s42, s52
    s_add_u32 s52, s52, s61
    s_and_b32 s52, s52, 15
    s_mul_i32 s62, s52, 131072
    s_add_u32 s62, s62, s46
    s_mul_i32 s63, s52, 128
    s_add_u32 s63, s63, s47
    s_lshr_b32 s53, s54, 4
    s_mul_i32 s52, s53, s69
    s_add_u32 s62, s62, s52
    buffer_load_dwordx4 v18, s[24:27], s48 offen offset:2048  lds
    buffer_load_dwordx4 v19, s[24:27], s48 offen offset:3072  lds
    s_mov_b32 m0, s56
    s_nop 0
    buffer_load_dwordx4 v20, s[28:31], s49 offen offset:0  lds
    s_add_u32 s55, s55, 16384
    s_add_u32 s56, s56, 32768
    s_cmp_eq_u32 s55, s57
    s_cselect_b32 s55, s50, s55
    s_cselect_b32 s56, s51, s56
    s_cmp_lt_u32 s54, 32
    s_cselect_b32 s64, 1, 0
    buffer_load_dwordx4 v21, s[28:31], s49 offen offset:1024  lds
    buffer_load_dwordx4 v22, s[28:31], s49 offen offset:2048  lds
    buffer_load_dwordx4 v23, s[28:31], s49 offen offset:3072  lds
    s_add_u32 m0, m0, 4096
    s_add_u32 s49, s49, 65536
    buffer_load_dwordx4 v20, s[28:31], s49 offen offset:0  lds
    buffer_load_dwordx4 v21, s[28:31], s49 offen offset:1024  lds
    buffer_load_dwordx4 v22, s[28:31], s49 offen offset:2048  lds
    buffer_load_dwordx4 v23, s[28:31], s49 offen offset:3072  lds
    s_cmp_eq_u32 s64, 1
    s_waitcnt vmcnt(12)
    s_barrier
    s_cbranch_scc1 L_quip_kernela1_go
    s_waitcnt vmcnt(0)
    s_barrier
    s_barrier
    s_endpgm
L_quip_kernel_A1c:
    s_lshl_b32 s70, s66, 7
    s_lshl_b32 s52, s42, 4
    s_add_u32 s70, s70, s52
    s_lshl_b32 s52, s43, 2
    s_add_u32 s70, s70, s52
    s_add_u32 s70, s70, 22151168
    v_lshrrev_b32 v5, 2, v3
    v_lshl_add_u32 v6, v4, 3, v5
    v_lshlrev_b32 v6, 8, v6
    v_and_b32 v7, 3, v2
    v_lshl_add_u32 v6, v7, 3, v6
    v_add_u32 v6, 0, v6
    v_and_b32 v7, 1, v4
    v_lshl_or_b32 v5, v7, 2, v5
    s_mul_i32 s52, s44, 4
    s_add_u32 s53, s52, 0
    v_xor_b32 v7, s53, v5
    v_lshl_add_u32 v16, v7, 5, v6
    s_add_u32 s53, s52, 1
    v_xor_b32 v7, s53, v5
    v_lshl_add_u32 v17, v7, 5, v6
    s_add_u32 s53, s52, 2
    v_xor_b32 v7, s53, v5
    v_lshl_add_u32 v18, v7, 5, v6
    s_add_u32 s53, s52, 3
    v_xor_b32 v7, s53, v5
    v_lshl_add_u32 v19, v7, 5, v6
    s_mul_i32 s52, s45, 16384
    s_add_u32 s52, s52, 49152
    v_lshl_add_u32 v5, v3, 7, s52
    v_lshrrev_b32 v6, 1, v3
    v_xor_b32 v6, v6, v4
    v_lshl_add_u32 v20, v6, 4, v5
    v_xor_b32 v6, 4, v6
    v_lshl_add_u32 v21, v6, 4, v5
    v_add_u32 v22, 65536, v20
    v_add_u32 v23, 65536, v21
    s_mov_b32 s57, 0
    s_mov_b32 s58, 0
    s_barrier
    ds_read_b64_tr_b16 v[24:25], v16 offset:0
    ds_read_b64_tr_b16 v[26:27], v16 offset:1024
    ds_read_b64_tr_b16 v[28:29], v17 offset:0
    ds_read_b64_tr_b16 v[30:31], v17 offset:1024
    ds_read_b64_tr_b16 v[32:33], v18 offset:0
    ds_read_b64_tr_b16 v[34:35], v18 offset:1024
    ds_read_b64_tr_b16 v[36:37], v19 offset:0
    ds_read_b64_tr_b16 v[38:39], v19 offset:1024
    ds_read_b128 v[40:43], v20 offset:0
    ds_read_b128 v[44:47], v20 offset:2048
    ds_read_b128 v[48:51], v20 offset:4096
    ds_read_b128 v[52:55], v20 offset:6144
    ds_read_b128 v[56:59], v20 offset:8192
    ds_read_b128 v[60:63], v20 offset:10240
    ds_read_b128 v[64:67], v20 offset:12288
    ds_read_b128 v[68:71], v20 offset:14336
    s_waitcnt lgkmcnt(0)
    v_mfma_f32_16x16x32_bf16 v[120:123], v[24:27], v[40:43], 0
    ds_read_b64_tr_b16 v[72:73], v16 offset:8192
    v_mfma_f32_16x16x32_bf16 v[152:155], v[28:31], v[40:43], 0
    ds_read_b64_tr_b16 v[74:75], v16 offset:9216
    v_mfma_f32_16x16x32_bf16 v[156:159], v[28:31], v[44:47], 0
    ds_read_b64_tr_b16 v[76:77], v17 offset:8192
    v_mfma_f32_16x16x32_bf16 v[124:127], v[24:27], v[44:47], 0
    ds_read_b64_tr_b16 v[78:79], v17 offset:9216
    v_mfma_f32_16x16x32_bf16 v[128:131], v[24:27], v[48:51], 0
    ds_read_b64_tr_b16 v[80:81], v18 offset:8192
    v_mfma_f32_16x16x32_bf16 v[160:163], v[28:31], v[48:51], 0
    ds_read_b64_tr_b16 v[82:83], v18 offset:9216
    v_mfma_f32_16x16x32_bf16 v[164:167], v[28:31], v[52:55], 0
    ds_read_b64_tr_b16 v[84:85], v19 offset:8192
    v_mfma_f32_16x16x32_bf16 v[132:135], v[24:27], v[52:55], 0
    ds_read_b64_tr_b16 v[86:87], v19 offset:9216
    v_mfma_f32_16x16x32_bf16 v[136:139], v[24:27], v[56:59], 0
    ds_read_b128 v[88:91], v21 offset:0
    v_mfma_f32_16x16x32_bf16 v[168:171], v[28:31], v[56:59], 0
    ds_read_b128 v[92:95], v21 offset:2048
    v_mfma_f32_16x16x32_bf16 v[172:175], v[28:31], v[60:63], 0
    ds_read_b128 v[96:99], v21 offset:4096
    v_mfma_f32_16x16x32_bf16 v[140:143], v[24:27], v[60:63], 0
    ds_read_b128 v[100:103], v21 offset:6144
    v_mfma_f32_16x16x32_bf16 v[144:147], v[24:27], v[64:67], 0
    ds_read_b128 v[104:107], v21 offset:8192
    v_mfma_f32_16x16x32_bf16 v[176:179], v[28:31], v[64:67], 0
    ds_read_b128 v[108:111], v21 offset:10240
    v_mfma_f32_16x16x32_bf16 v[180:183], v[28:31], v[68:71], 0
    ds_read_b128 v[112:115], v21 offset:12288
    v_mfma_f32_16x16x32_bf16 v[148:151], v[24:27], v[68:71], 0
    ds_read_b128 v[116:119], v21 offset:14336
    v_mfma_f32_16x16x32_bf16 v[212:215], v[32:35], v[68:71], 0
    s_mov_b32 s57, 1
    s_cmp_eq_u32 s57, 1
    v_mfma_f32_16x16x32_bf16 v[244:247], v[36:39], v[68:71], 0
    v_mfma_f32_16x16x32_bf16 v[240:243], v[36:39], v[64:67], 0
    v_mfma_f32_16x16x32_bf16 v[208:211], v[32:35], v[64:67], 0
    v_mfma_f32_16x16x32_bf16 v[204:207], v[32:35], v[60:63], 0
    v_mfma_f32_16x16x32_bf16 v[236:239], v[36:39], v[60:63], 0
    v_mfma_f32_16x16x32_bf16 v[232:235], v[36:39], v[56:59], 0
    v_mfma_f32_16x16x32_bf16 v[200:203], v[32:35], v[56:59], 0
    v_mfma_f32_16x16x32_bf16 v[196:199], v[32:35], v[52:55], 0
    v_mfma_f32_16x16x32_bf16 v[228:231], v[36:39], v[52:55], 0
    v_mfma_f32_16x16x32_bf16 v[224:227], v[36:39], v[48:51], 0
    v_mfma_f32_16x16x32_bf16 v[192:195], v[32:35], v[48:51], 0
    v_mfma_f32_16x16x32_bf16 v[188:191], v[32:35], v[44:47], 0
    v_mfma_f32_16x16x32_bf16 v[220:223], v[36:39], v[44:47], 0
    v_mfma_f32_16x16x32_bf16 v[216:219], v[36:39], v[40:43], 0
    v_mfma_f32_16x16x32_bf16 v[184:187], v[32:35], v[40:43], 0
    s_branch L_quip_kernela1_m0
.p2align 6
L_quip_kernela1_c0:
    s_cmp_eq_u32 s58, 1
    s_cbranch_scc1 L_quip_kernela1_fl
L_quip_kernela1_flb:
    s_waitcnt lgkmcnt(0)
    v_mfma_f32_16x16x32_bf16 v[120:123], v[24:27], v[40:43], v[120:123]
    ds_read_b64_tr_b16 v[72:73], v16 offset:8192
    v_mfma_f32_16x16x32_bf16 v[152:155], v[28:31], v[40:43], v[152:155]
    ds_read_b64_tr_b16 v[74:75], v16 offset:9216
    v_mfma_f32_16x16x32_bf16 v[156:159], v[28:31], v[44:47], v[156:159]
    ds_read_b64_tr_b16 v[76:77], v17 offset:8192
    v_mfma_f32_16x16x32_bf16 v[124:127], v[24:27], v[44:47], v[124:127]
    ds_read_b64_tr_b16 v[78:79], v17 offset:9216
    v_mfma_f32_16x16x32_bf16 v[128:131], v[24:27], v[48:51], v[128:131]
    ds_read_b64_tr_b16 v[80:81], v18 offset:8192
    v_mfma_f32_16x16x32_bf16 v[160:163], v[28:31], v[48:51], v[160:163]
    ds_read_b64_tr_b16 v[82:83], v18 offset:9216
    v_mfma_f32_16x16x32_bf16 v[164:167], v[28:31], v[52:55], v[164:167]
    ds_read_b64_tr_b16 v[84:85], v19 offset:8192
    v_mfma_f32_16x16x32_bf16 v[132:135], v[24:27], v[52:55], v[132:135]
    ds_read_b64_tr_b16 v[86:87], v19 offset:9216
    v_mfma_f32_16x16x32_bf16 v[136:139], v[24:27], v[56:59], v[136:139]
    ds_read_b128 v[88:91], v21 offset:0
    v_mfma_f32_16x16x32_bf16 v[168:171], v[28:31], v[56:59], v[168:171]
    ds_read_b128 v[92:95], v21 offset:2048
    v_mfma_f32_16x16x32_bf16 v[172:175], v[28:31], v[60:63], v[172:175]
    ds_read_b128 v[96:99], v21 offset:4096
    v_mfma_f32_16x16x32_bf16 v[140:143], v[24:27], v[60:63], v[140:143]
    ds_read_b128 v[100:103], v21 offset:6144
    v_mfma_f32_16x16x32_bf16 v[144:147], v[24:27], v[64:67], v[144:147]
    ds_read_b128 v[104:107], v21 offset:8192
    v_mfma_f32_16x16x32_bf16 v[176:179], v[28:31], v[64:67], v[176:179]
    ds_read_b128 v[108:111], v21 offset:10240
    v_mfma_f32_16x16x32_bf16 v[180:183], v[28:31], v[68:71], v[180:183]
    ds_read_b128 v[112:115], v21 offset:12288
    v_mfma_f32_16x16x32_bf16 v[148:151], v[24:27], v[68:71], v[148:151]
    ds_read_b128 v[116:119], v21 offset:14336
    v_mfma_f32_16x16x32_bf16 v[212:215], v[32:35], v[68:71], v[212:215]
    s_add_u32 s57, s57, 1
    s_cmp_lt_u32 s57, 16
    v_mfma_f32_16x16x32_bf16 v[244:247], v[36:39], v[68:71], v[244:247]
    v_mfma_f32_16x16x32_bf16 v[240:243], v[36:39], v[64:67], v[240:243]
    v_mfma_f32_16x16x32_bf16 v[208:211], v[32:35], v[64:67], v[208:211]
    v_mfma_f32_16x16x32_bf16 v[204:207], v[32:35], v[60:63], v[204:207]
    v_mfma_f32_16x16x32_bf16 v[236:239], v[36:39], v[60:63], v[236:239]
    v_mfma_f32_16x16x32_bf16 v[232:235], v[36:39], v[56:59], v[232:235]
    v_mfma_f32_16x16x32_bf16 v[200:203], v[32:35], v[56:59], v[200:203]
    v_mfma_f32_16x16x32_bf16 v[196:199], v[32:35], v[52:55], v[196:199]
    v_mfma_f32_16x16x32_bf16 v[228:231], v[36:39], v[52:55], v[228:231]
    v_mfma_f32_16x16x32_bf16 v[224:227], v[36:39], v[48:51], v[224:227]
    v_mfma_f32_16x16x32_bf16 v[192:195], v[32:35], v[48:51], v[192:195]
    v_mfma_f32_16x16x32_bf16 v[188:191], v[32:35], v[44:47], v[188:191]
    v_mfma_f32_16x16x32_bf16 v[220:223], v[36:39], v[44:47], v[220:223]
    v_mfma_f32_16x16x32_bf16 v[216:219], v[36:39], v[40:43], v[216:219]
    v_mfma_f32_16x16x32_bf16 v[184:187], v[32:35], v[40:43], v[184:187]
L_quip_kernela1_m0:
    s_waitcnt lgkmcnt(0)
    s_barrier
    v_mfma_f32_16x16x32_bf16 v[120:123], v[72:75], v[88:91], v[120:123]
    ds_read_b64_tr_b16 v[24:25], v16 offset:16384
    v_mfma_f32_16x16x32_bf16 v[152:155], v[76:79], v[88:91], v[152:155]
    ds_read_b64_tr_b16 v[26:27], v16 offset:17408
    v_mfma_f32_16x16x32_bf16 v[156:159], v[76:79], v[92:95], v[156:159]
    ds_read_b64_tr_b16 v[28:29], v17 offset:16384
    v_mfma_f32_16x16x32_bf16 v[124:127], v[72:75], v[92:95], v[124:127]
    ds_read_b64_tr_b16 v[30:31], v17 offset:17408
    v_mfma_f32_16x16x32_bf16 v[128:131], v[72:75], v[96:99], v[128:131]
    ds_read_b64_tr_b16 v[32:33], v18 offset:16384
    v_mfma_f32_16x16x32_bf16 v[160:163], v[76:79], v[96:99], v[160:163]
    ds_read_b64_tr_b16 v[34:35], v18 offset:17408
    v_mfma_f32_16x16x32_bf16 v[164:167], v[76:79], v[100:103], v[164:167]
    ds_read_b64_tr_b16 v[36:37], v19 offset:16384
    v_mfma_f32_16x16x32_bf16 v[132:135], v[72:75], v[100:103], v[132:135]
    ds_read_b64_tr_b16 v[38:39], v19 offset:17408
    v_mfma_f32_16x16x32_bf16 v[136:139], v[72:75], v[104:107], v[136:139]
    ds_read_b128 v[40:43], v20 offset:32768
    v_mfma_f32_16x16x32_bf16 v[168:171], v[76:79], v[104:107], v[168:171]
    ds_read_b128 v[44:47], v20 offset:34816
    v_mfma_f32_16x16x32_bf16 v[172:175], v[76:79], v[108:111], v[172:175]
    ds_read_b128 v[48:51], v20 offset:36864
    v_mfma_f32_16x16x32_bf16 v[140:143], v[72:75], v[108:111], v[140:143]
    ds_read_b128 v[52:55], v20 offset:38912
    v_mfma_f32_16x16x32_bf16 v[144:147], v[72:75], v[112:115], v[144:147]
    ds_read_b128 v[56:59], v20 offset:40960
    v_mfma_f32_16x16x32_bf16 v[176:179], v[76:79], v[112:115], v[176:179]
    ds_read_b128 v[60:63], v20 offset:43008
    v_mfma_f32_16x16x32_bf16 v[180:183], v[76:79], v[116:119], v[180:183]
    ds_read_b128 v[64:67], v20 offset:45056
    v_mfma_f32_16x16x32_bf16 v[148:151], v[72:75], v[116:119], v[148:151]
    ds_read_b128 v[68:71], v20 offset:47104
    v_mfma_f32_16x16x32_bf16 v[212:215], v[80:83], v[116:119], v[212:215]
    v_mfma_f32_16x16x32_bf16 v[244:247], v[84:87], v[116:119], v[244:247]
    v_mfma_f32_16x16x32_bf16 v[240:243], v[84:87], v[112:115], v[240:243]
    v_mfma_f32_16x16x32_bf16 v[208:211], v[80:83], v[112:115], v[208:211]
    v_mfma_f32_16x16x32_bf16 v[204:207], v[80:83], v[108:111], v[204:207]
    v_mfma_f32_16x16x32_bf16 v[236:239], v[84:87], v[108:111], v[236:239]
    v_mfma_f32_16x16x32_bf16 v[232:235], v[84:87], v[104:107], v[232:235]
    v_mfma_f32_16x16x32_bf16 v[200:203], v[80:83], v[104:107], v[200:203]
    v_mfma_f32_16x16x32_bf16 v[196:199], v[80:83], v[100:103], v[196:199]
    v_mfma_f32_16x16x32_bf16 v[228:231], v[84:87], v[100:103], v[228:231]
    v_mfma_f32_16x16x32_bf16 v[224:227], v[84:87], v[96:99], v[224:227]
    v_mfma_f32_16x16x32_bf16 v[192:195], v[80:83], v[96:99], v[192:195]
    v_mfma_f32_16x16x32_bf16 v[188:191], v[80:83], v[92:95], v[188:191]
    v_mfma_f32_16x16x32_bf16 v[220:223], v[84:87], v[92:95], v[220:223]
    v_mfma_f32_16x16x32_bf16 v[216:219], v[84:87], v[88:91], v[216:219]
    v_mfma_f32_16x16x32_bf16 v[184:187], v[80:83], v[88:91], v[184:187]
    s_cbranch_scc0 L_quip_kernela1_done
L_quip_kernela1_c1:
    s_waitcnt lgkmcnt(0)
    v_mfma_f32_16x16x32_bf16 v[120:123], v[24:27], v[40:43], v[120:123]
    ds_read_b64_tr_b16 v[72:73], v16 offset:24576
    v_mfma_f32_16x16x32_bf16 v[152:155], v[28:31], v[40:43], v[152:155]
    ds_read_b64_tr_b16 v[74:75], v16 offset:25600
    v_mfma_f32_16x16x32_bf16 v[156:159], v[28:31], v[44:47], v[156:159]
    ds_read_b64_tr_b16 v[76:77], v17 offset:24576
    v_mfma_f32_16x16x32_bf16 v[124:127], v[24:27], v[44:47], v[124:127]
    ds_read_b64_tr_b16 v[78:79], v17 offset:25600
    v_mfma_f32_16x16x32_bf16 v[128:131], v[24:27], v[48:51], v[128:131]
    ds_read_b64_tr_b16 v[80:81], v18 offset:24576
    v_mfma_f32_16x16x32_bf16 v[160:163], v[28:31], v[48:51], v[160:163]
    ds_read_b64_tr_b16 v[82:83], v18 offset:25600
    v_mfma_f32_16x16x32_bf16 v[164:167], v[28:31], v[52:55], v[164:167]
    ds_read_b64_tr_b16 v[84:85], v19 offset:24576
    v_mfma_f32_16x16x32_bf16 v[132:135], v[24:27], v[52:55], v[132:135]
    ds_read_b64_tr_b16 v[86:87], v19 offset:25600
    v_mfma_f32_16x16x32_bf16 v[136:139], v[24:27], v[56:59], v[136:139]
    ds_read_b128 v[88:91], v21 offset:32768
    v_mfma_f32_16x16x32_bf16 v[168:171], v[28:31], v[56:59], v[168:171]
    ds_read_b128 v[92:95], v21 offset:34816
    v_mfma_f32_16x16x32_bf16 v[172:175], v[28:31], v[60:63], v[172:175]
    ds_read_b128 v[96:99], v21 offset:36864
    v_mfma_f32_16x16x32_bf16 v[140:143], v[24:27], v[60:63], v[140:143]
    ds_read_b128 v[100:103], v21 offset:38912
    v_mfma_f32_16x16x32_bf16 v[144:147], v[24:27], v[64:67], v[144:147]
    ds_read_b128 v[104:107], v21 offset:40960
    v_mfma_f32_16x16x32_bf16 v[176:179], v[28:31], v[64:67], v[176:179]
    ds_read_b128 v[108:111], v21 offset:43008
    v_mfma_f32_16x16x32_bf16 v[180:183], v[28:31], v[68:71], v[180:183]
    ds_read_b128 v[112:115], v21 offset:45056
    v_mfma_f32_16x16x32_bf16 v[148:151], v[24:27], v[68:71], v[148:151]
    ds_read_b128 v[116:119], v21 offset:47104
    v_mfma_f32_16x16x32_bf16 v[212:215], v[32:35], v[68:71], v[212:215]
    s_add_u32 s57, s57, 1
    s_cmp_lt_u32 s57, 16
    v_mfma_f32_16x16x32_bf16 v[244:247], v[36:39], v[68:71], v[244:247]
    v_mfma_f32_16x16x32_bf16 v[240:243], v[36:39], v[64:67], v[240:243]
    v_mfma_f32_16x16x32_bf16 v[208:211], v[32:35], v[64:67], v[208:211]
    v_mfma_f32_16x16x32_bf16 v[204:207], v[32:35], v[60:63], v[204:207]
    v_mfma_f32_16x16x32_bf16 v[236:239], v[36:39], v[60:63], v[236:239]
    v_mfma_f32_16x16x32_bf16 v[232:235], v[36:39], v[56:59], v[232:235]
    v_mfma_f32_16x16x32_bf16 v[200:203], v[32:35], v[56:59], v[200:203]
    v_mfma_f32_16x16x32_bf16 v[196:199], v[32:35], v[52:55], v[196:199]
    v_mfma_f32_16x16x32_bf16 v[228:231], v[36:39], v[52:55], v[228:231]
    v_mfma_f32_16x16x32_bf16 v[224:227], v[36:39], v[48:51], v[224:227]
    v_mfma_f32_16x16x32_bf16 v[192:195], v[32:35], v[48:51], v[192:195]
    v_mfma_f32_16x16x32_bf16 v[188:191], v[32:35], v[44:47], v[188:191]
    v_mfma_f32_16x16x32_bf16 v[220:223], v[36:39], v[44:47], v[220:223]
    v_mfma_f32_16x16x32_bf16 v[216:219], v[36:39], v[40:43], v[216:219]
    v_mfma_f32_16x16x32_bf16 v[184:187], v[32:35], v[40:43], v[184:187]
L_quip_kernela1_m1:
    s_waitcnt lgkmcnt(0)
    s_barrier
    v_mfma_f32_16x16x32_bf16 v[120:123], v[72:75], v[88:91], v[120:123]
    ds_read_b64_tr_b16 v[24:25], v16 offset:32768
    v_mfma_f32_16x16x32_bf16 v[152:155], v[76:79], v[88:91], v[152:155]
    ds_read_b64_tr_b16 v[26:27], v16 offset:33792
    v_mfma_f32_16x16x32_bf16 v[156:159], v[76:79], v[92:95], v[156:159]
    ds_read_b64_tr_b16 v[28:29], v17 offset:32768
    v_mfma_f32_16x16x32_bf16 v[124:127], v[72:75], v[92:95], v[124:127]
    ds_read_b64_tr_b16 v[30:31], v17 offset:33792
    v_mfma_f32_16x16x32_bf16 v[128:131], v[72:75], v[96:99], v[128:131]
    ds_read_b64_tr_b16 v[32:33], v18 offset:32768
    v_mfma_f32_16x16x32_bf16 v[160:163], v[76:79], v[96:99], v[160:163]
    ds_read_b64_tr_b16 v[34:35], v18 offset:33792
    v_mfma_f32_16x16x32_bf16 v[164:167], v[76:79], v[100:103], v[164:167]
    ds_read_b64_tr_b16 v[36:37], v19 offset:32768
    v_mfma_f32_16x16x32_bf16 v[132:135], v[72:75], v[100:103], v[132:135]
    ds_read_b64_tr_b16 v[38:39], v19 offset:33792
    v_mfma_f32_16x16x32_bf16 v[136:139], v[72:75], v[104:107], v[136:139]
    ds_read_b128 v[40:43], v22 offset:0
    v_mfma_f32_16x16x32_bf16 v[168:171], v[76:79], v[104:107], v[168:171]
    ds_read_b128 v[44:47], v22 offset:2048
    v_mfma_f32_16x16x32_bf16 v[172:175], v[76:79], v[108:111], v[172:175]
    ds_read_b128 v[48:51], v22 offset:4096
    v_mfma_f32_16x16x32_bf16 v[140:143], v[72:75], v[108:111], v[140:143]
    ds_read_b128 v[52:55], v22 offset:6144
    v_mfma_f32_16x16x32_bf16 v[144:147], v[72:75], v[112:115], v[144:147]
    ds_read_b128 v[56:59], v22 offset:8192
    v_mfma_f32_16x16x32_bf16 v[176:179], v[76:79], v[112:115], v[176:179]
    ds_read_b128 v[60:63], v22 offset:10240
    v_mfma_f32_16x16x32_bf16 v[180:183], v[76:79], v[116:119], v[180:183]
    ds_read_b128 v[64:67], v22 offset:12288
    v_mfma_f32_16x16x32_bf16 v[148:151], v[72:75], v[116:119], v[148:151]
    ds_read_b128 v[68:71], v22 offset:14336
    v_mfma_f32_16x16x32_bf16 v[212:215], v[80:83], v[116:119], v[212:215]
    v_mfma_f32_16x16x32_bf16 v[244:247], v[84:87], v[116:119], v[244:247]
    v_mfma_f32_16x16x32_bf16 v[240:243], v[84:87], v[112:115], v[240:243]
    v_mfma_f32_16x16x32_bf16 v[208:211], v[80:83], v[112:115], v[208:211]
    v_mfma_f32_16x16x32_bf16 v[204:207], v[80:83], v[108:111], v[204:207]
    v_mfma_f32_16x16x32_bf16 v[236:239], v[84:87], v[108:111], v[236:239]
    v_mfma_f32_16x16x32_bf16 v[232:235], v[84:87], v[104:107], v[232:235]
    v_mfma_f32_16x16x32_bf16 v[200:203], v[80:83], v[104:107], v[200:203]
    v_mfma_f32_16x16x32_bf16 v[196:199], v[80:83], v[100:103], v[196:199]
    v_mfma_f32_16x16x32_bf16 v[228:231], v[84:87], v[100:103], v[228:231]
    v_mfma_f32_16x16x32_bf16 v[224:227], v[84:87], v[96:99], v[224:227]
    v_mfma_f32_16x16x32_bf16 v[192:195], v[80:83], v[96:99], v[192:195]
    v_mfma_f32_16x16x32_bf16 v[188:191], v[80:83], v[92:95], v[188:191]
    v_mfma_f32_16x16x32_bf16 v[220:223], v[84:87], v[92:95], v[220:223]
    v_mfma_f32_16x16x32_bf16 v[216:219], v[84:87], v[88:91], v[216:219]
    v_mfma_f32_16x16x32_bf16 v[184:187], v[80:83], v[88:91], v[184:187]
    s_cbranch_scc0 L_quip_kernela1_done
L_quip_kernela1_c2:
    s_waitcnt lgkmcnt(0)
    v_mfma_f32_16x16x32_bf16 v[120:123], v[24:27], v[40:43], v[120:123]
    ds_read_b64_tr_b16 v[72:73], v16 offset:40960
    v_mfma_f32_16x16x32_bf16 v[152:155], v[28:31], v[40:43], v[152:155]
    ds_read_b64_tr_b16 v[74:75], v16 offset:41984
    v_mfma_f32_16x16x32_bf16 v[156:159], v[28:31], v[44:47], v[156:159]
    ds_read_b64_tr_b16 v[76:77], v17 offset:40960
    v_mfma_f32_16x16x32_bf16 v[124:127], v[24:27], v[44:47], v[124:127]
    ds_read_b64_tr_b16 v[78:79], v17 offset:41984
    v_mfma_f32_16x16x32_bf16 v[128:131], v[24:27], v[48:51], v[128:131]
    ds_read_b64_tr_b16 v[80:81], v18 offset:40960
    v_mfma_f32_16x16x32_bf16 v[160:163], v[28:31], v[48:51], v[160:163]
    ds_read_b64_tr_b16 v[82:83], v18 offset:41984
    v_mfma_f32_16x16x32_bf16 v[164:167], v[28:31], v[52:55], v[164:167]
    ds_read_b64_tr_b16 v[84:85], v19 offset:40960
    v_mfma_f32_16x16x32_bf16 v[132:135], v[24:27], v[52:55], v[132:135]
    ds_read_b64_tr_b16 v[86:87], v19 offset:41984
    v_mfma_f32_16x16x32_bf16 v[136:139], v[24:27], v[56:59], v[136:139]
    ds_read_b128 v[88:91], v23 offset:0
    v_mfma_f32_16x16x32_bf16 v[168:171], v[28:31], v[56:59], v[168:171]
    ds_read_b128 v[92:95], v23 offset:2048
    v_mfma_f32_16x16x32_bf16 v[172:175], v[28:31], v[60:63], v[172:175]
    ds_read_b128 v[96:99], v23 offset:4096
    v_mfma_f32_16x16x32_bf16 v[140:143], v[24:27], v[60:63], v[140:143]
    ds_read_b128 v[100:103], v23 offset:6144
    v_mfma_f32_16x16x32_bf16 v[144:147], v[24:27], v[64:67], v[144:147]
    ds_read_b128 v[104:107], v23 offset:8192
    v_mfma_f32_16x16x32_bf16 v[176:179], v[28:31], v[64:67], v[176:179]
    ds_read_b128 v[108:111], v23 offset:10240
    v_mfma_f32_16x16x32_bf16 v[180:183], v[28:31], v[68:71], v[180:183]
    ds_read_b128 v[112:115], v23 offset:12288
    v_mfma_f32_16x16x32_bf16 v[148:151], v[24:27], v[68:71], v[148:151]
    ds_read_b128 v[116:119], v23 offset:14336
    v_mfma_f32_16x16x32_bf16 v[212:215], v[32:35], v[68:71], v[212:215]
    s_add_u32 s57, s57, 1
    s_cmp_lt_u32 s57, 16
    v_mfma_f32_16x16x32_bf16 v[244:247], v[36:39], v[68:71], v[244:247]
    v_mfma_f32_16x16x32_bf16 v[240:243], v[36:39], v[64:67], v[240:243]
    v_mfma_f32_16x16x32_bf16 v[208:211], v[32:35], v[64:67], v[208:211]
    v_mfma_f32_16x16x32_bf16 v[204:207], v[32:35], v[60:63], v[204:207]
    v_mfma_f32_16x16x32_bf16 v[236:239], v[36:39], v[60:63], v[236:239]
    v_mfma_f32_16x16x32_bf16 v[232:235], v[36:39], v[56:59], v[232:235]
    v_mfma_f32_16x16x32_bf16 v[200:203], v[32:35], v[56:59], v[200:203]
    v_mfma_f32_16x16x32_bf16 v[196:199], v[32:35], v[52:55], v[196:199]
    v_mfma_f32_16x16x32_bf16 v[228:231], v[36:39], v[52:55], v[228:231]
    v_mfma_f32_16x16x32_bf16 v[224:227], v[36:39], v[48:51], v[224:227]
    v_mfma_f32_16x16x32_bf16 v[192:195], v[32:35], v[48:51], v[192:195]
    v_mfma_f32_16x16x32_bf16 v[188:191], v[32:35], v[44:47], v[188:191]
    v_mfma_f32_16x16x32_bf16 v[220:223], v[36:39], v[44:47], v[220:223]
    v_mfma_f32_16x16x32_bf16 v[216:219], v[36:39], v[40:43], v[216:219]
    v_mfma_f32_16x16x32_bf16 v[184:187], v[32:35], v[40:43], v[184:187]
L_quip_kernela1_m2:
    s_waitcnt lgkmcnt(0)
    s_barrier
    v_mfma_f32_16x16x32_bf16 v[120:123], v[72:75], v[88:91], v[120:123]
    ds_read_b64_tr_b16 v[24:25], v16 offset:0
    v_mfma_f32_16x16x32_bf16 v[152:155], v[76:79], v[88:91], v[152:155]
    ds_read_b64_tr_b16 v[26:27], v16 offset:1024
    v_mfma_f32_16x16x32_bf16 v[156:159], v[76:79], v[92:95], v[156:159]
    ds_read_b64_tr_b16 v[28:29], v17 offset:0
    v_mfma_f32_16x16x32_bf16 v[124:127], v[72:75], v[92:95], v[124:127]
    ds_read_b64_tr_b16 v[30:31], v17 offset:1024
    v_mfma_f32_16x16x32_bf16 v[128:131], v[72:75], v[96:99], v[128:131]
    ds_read_b64_tr_b16 v[32:33], v18 offset:0
    v_mfma_f32_16x16x32_bf16 v[160:163], v[76:79], v[96:99], v[160:163]
    ds_read_b64_tr_b16 v[34:35], v18 offset:1024
    v_mfma_f32_16x16x32_bf16 v[164:167], v[76:79], v[100:103], v[164:167]
    ds_read_b64_tr_b16 v[36:37], v19 offset:0
    v_mfma_f32_16x16x32_bf16 v[132:135], v[72:75], v[100:103], v[132:135]
    ds_read_b64_tr_b16 v[38:39], v19 offset:1024
    v_mfma_f32_16x16x32_bf16 v[136:139], v[72:75], v[104:107], v[136:139]
    ds_read_b128 v[40:43], v20 offset:0
    v_mfma_f32_16x16x32_bf16 v[168:171], v[76:79], v[104:107], v[168:171]
    ds_read_b128 v[44:47], v20 offset:2048
    v_mfma_f32_16x16x32_bf16 v[172:175], v[76:79], v[108:111], v[172:175]
    ds_read_b128 v[48:51], v20 offset:4096
    v_mfma_f32_16x16x32_bf16 v[140:143], v[72:75], v[108:111], v[140:143]
    ds_read_b128 v[52:55], v20 offset:6144
    v_mfma_f32_16x16x32_bf16 v[144:147], v[72:75], v[112:115], v[144:147]
    ds_read_b128 v[56:59], v20 offset:8192
    v_mfma_f32_16x16x32_bf16 v[176:179], v[76:79], v[112:115], v[176:179]
    ds_read_b128 v[60:63], v20 offset:10240
    v_mfma_f32_16x16x32_bf16 v[180:183], v[76:79], v[116:119], v[180:183]
    ds_read_b128 v[64:67], v20 offset:12288
    v_mfma_f32_16x16x32_bf16 v[148:151], v[72:75], v[116:119], v[148:151]
    ds_read_b128 v[68:71], v20 offset:14336
    v_mfma_f32_16x16x32_bf16 v[212:215], v[80:83], v[116:119], v[212:215]
    v_mfma_f32_16x16x32_bf16 v[244:247], v[84:87], v[116:119], v[244:247]
    v_mfma_f32_16x16x32_bf16 v[240:243], v[84:87], v[112:115], v[240:243]
    v_mfma_f32_16x16x32_bf16 v[208:211], v[80:83], v[112:115], v[208:211]
    v_mfma_f32_16x16x32_bf16 v[204:207], v[80:83], v[108:111], v[204:207]
    v_mfma_f32_16x16x32_bf16 v[236:239], v[84:87], v[108:111], v[236:239]
    v_mfma_f32_16x16x32_bf16 v[232:235], v[84:87], v[104:107], v[232:235]
    v_mfma_f32_16x16x32_bf16 v[200:203], v[80:83], v[104:107], v[200:203]
    v_mfma_f32_16x16x32_bf16 v[196:199], v[80:83], v[100:103], v[196:199]
    v_mfma_f32_16x16x32_bf16 v[228:231], v[84:87], v[100:103], v[228:231]
    v_mfma_f32_16x16x32_bf16 v[224:227], v[84:87], v[96:99], v[224:227]
    v_mfma_f32_16x16x32_bf16 v[192:195], v[80:83], v[96:99], v[192:195]
    v_mfma_f32_16x16x32_bf16 v[188:191], v[80:83], v[92:95], v[188:191]
    v_mfma_f32_16x16x32_bf16 v[220:223], v[84:87], v[92:95], v[220:223]
    v_mfma_f32_16x16x32_bf16 v[216:219], v[84:87], v[88:91], v[216:219]
    v_mfma_f32_16x16x32_bf16 v[184:187], v[80:83], v[88:91], v[184:187]
    s_cbranch_scc1 L_quip_kernela1_c0
L_quip_kernela1_done:
    s_nop 7
    s_nop 1
    v_lshlrev_b32 v5, 4, v2
    s_lshl_b32 s52, s41, 5
    s_lshl_b32 s53, s40, 2
    s_add_u32 s52, s52, s53
    s_lshl_b32 s53, s44, 1
    s_add_u32 s52, s52, s53
    s_lshl_b32 s52, s52, 1
    s_add_u32 s52, s52, s45
    s_lshl_b32 s52, s52, 13
    s_add_u32 s52, s52, 8388608
    v_cvt_pk_bf16_f32 v72, v120, v121
    v_cvt_pk_bf16_f32 v73, v122, v123
    v_cvt_pk_bf16_f32 v74, v152, v153
    v_cvt_pk_bf16_f32 v75, v154, v155
    buffer_store_dwordx4 v[72:75], v5, s[32:35], s52 offen offset:0 sc1
    v_cvt_pk_bf16_f32 v76, v124, v125
    v_cvt_pk_bf16_f32 v77, v126, v127
    v_cvt_pk_bf16_f32 v78, v156, v157
    v_cvt_pk_bf16_f32 v79, v158, v159
    buffer_store_dwordx4 v[76:79], v5, s[32:35], s52 offen offset:1024 sc1
    v_cvt_pk_bf16_f32 v80, v128, v129
    v_cvt_pk_bf16_f32 v81, v130, v131
    v_cvt_pk_bf16_f32 v82, v160, v161
    v_cvt_pk_bf16_f32 v83, v162, v163
    buffer_store_dwordx4 v[80:83], v5, s[32:35], s52 offen offset:2048 sc1
    v_cvt_pk_bf16_f32 v84, v132, v133
    v_cvt_pk_bf16_f32 v85, v134, v135
    v_cvt_pk_bf16_f32 v86, v164, v165
    v_cvt_pk_bf16_f32 v87, v166, v167
    buffer_store_dwordx4 v[84:87], v5, s[32:35], s52 offen offset:3072 sc1
    s_add_u32 s53, s52, 4096
    v_cvt_pk_bf16_f32 v88, v136, v137
    v_cvt_pk_bf16_f32 v89, v138, v139
    v_cvt_pk_bf16_f32 v90, v168, v169
    v_cvt_pk_bf16_f32 v91, v170, v171
    buffer_store_dwordx4 v[88:91], v5, s[32:35], s53 offen offset:0 sc1
    v_cvt_pk_bf16_f32 v92, v140, v141
    v_cvt_pk_bf16_f32 v93, v142, v143
    v_cvt_pk_bf16_f32 v94, v172, v173
    v_cvt_pk_bf16_f32 v95, v174, v175
    buffer_store_dwordx4 v[92:95], v5, s[32:35], s53 offen offset:1024 sc1
    v_cvt_pk_bf16_f32 v96, v144, v145
    v_cvt_pk_bf16_f32 v97, v146, v147
    v_cvt_pk_bf16_f32 v98, v176, v177
    v_cvt_pk_bf16_f32 v99, v178, v179
    buffer_store_dwordx4 v[96:99], v5, s[32:35], s53 offen offset:2048 sc1
    v_cvt_pk_bf16_f32 v100, v148, v149
    v_cvt_pk_bf16_f32 v101, v150, v151
    v_cvt_pk_bf16_f32 v102, v180, v181
    v_cvt_pk_bf16_f32 v103, v182, v183
    buffer_store_dwordx4 v[100:103], v5, s[32:35], s53 offen offset:3072 sc1
    s_add_u32 s52, s52, 16384
    v_cvt_pk_bf16_f32 v72, v184, v185
    v_cvt_pk_bf16_f32 v73, v186, v187
    v_cvt_pk_bf16_f32 v74, v216, v217
    v_cvt_pk_bf16_f32 v75, v218, v219
    buffer_store_dwordx4 v[72:75], v5, s[32:35], s52 offen offset:0 sc1
    v_cvt_pk_bf16_f32 v76, v188, v189
    v_cvt_pk_bf16_f32 v77, v190, v191
    v_cvt_pk_bf16_f32 v78, v220, v221
    v_cvt_pk_bf16_f32 v79, v222, v223
    buffer_store_dwordx4 v[76:79], v5, s[32:35], s52 offen offset:1024 sc1
    v_cvt_pk_bf16_f32 v80, v192, v193
    v_cvt_pk_bf16_f32 v81, v194, v195
    v_cvt_pk_bf16_f32 v82, v224, v225
    v_cvt_pk_bf16_f32 v83, v226, v227
    buffer_store_dwordx4 v[80:83], v5, s[32:35], s52 offen offset:2048 sc1
    v_cvt_pk_bf16_f32 v84, v196, v197
    v_cvt_pk_bf16_f32 v85, v198, v199
    v_cvt_pk_bf16_f32 v86, v228, v229
    v_cvt_pk_bf16_f32 v87, v230, v231
    buffer_store_dwordx4 v[84:87], v5, s[32:35], s52 offen offset:3072 sc1
    s_add_u32 s53, s52, 4096
    v_cvt_pk_bf16_f32 v88, v200, v201
    v_cvt_pk_bf16_f32 v89, v202, v203
    v_cvt_pk_bf16_f32 v90, v232, v233
    v_cvt_pk_bf16_f32 v91, v234, v235
    buffer_store_dwordx4 v[88:91], v5, s[32:35], s53 offen offset:0 sc1
    v_cvt_pk_bf16_f32 v92, v204, v205
    v_cvt_pk_bf16_f32 v93, v206, v207
    v_cvt_pk_bf16_f32 v94, v236, v237
    v_cvt_pk_bf16_f32 v95, v238, v239
    buffer_store_dwordx4 v[92:95], v5, s[32:35], s53 offen offset:1024 sc1
    v_cvt_pk_bf16_f32 v96, v208, v209
    v_cvt_pk_bf16_f32 v97, v210, v211
    v_cvt_pk_bf16_f32 v98, v240, v241
    v_cvt_pk_bf16_f32 v99, v242, v243
    buffer_store_dwordx4 v[96:99], v5, s[32:35], s53 offen offset:2048 sc1
    v_cvt_pk_bf16_f32 v100, v212, v213
    v_cvt_pk_bf16_f32 v101, v214, v215
    v_cvt_pk_bf16_f32 v102, v244, v245
    v_cvt_pk_bf16_f32 v103, v246, v247
    buffer_store_dwordx4 v[100:103], v5, s[32:35], s53 offen offset:3072 sc1
    s_add_u32 s52, s52, 16384
    s_cmp_lg_u32 s58, 0
    s_cbranch_scc1 L_quip_kernela1_fin
    s_mov_b32 s58, 1
    s_xor_b32 s40, s40, 4
    v_mov_b32 v10, 0
    global_load_dword v11, v10, s[18:19] sc1
    s_waitcnt lgkmcnt(0)
    v_mfma_f32_16x16x32_bf16 v[120:123], v[24:27], v[40:43], 0
    ds_read_b64_tr_b16 v[72:73], v16 offset:24576
    v_mfma_f32_16x16x32_bf16 v[152:155], v[28:31], v[40:43], 0
    ds_read_b64_tr_b16 v[74:75], v16 offset:25600
    v_mfma_f32_16x16x32_bf16 v[156:159], v[28:31], v[44:47], 0
    ds_read_b64_tr_b16 v[76:77], v17 offset:24576
    v_mfma_f32_16x16x32_bf16 v[124:127], v[24:27], v[44:47], 0
    ds_read_b64_tr_b16 v[78:79], v17 offset:25600
    v_mfma_f32_16x16x32_bf16 v[128:131], v[24:27], v[48:51], 0
    ds_read_b64_tr_b16 v[80:81], v18 offset:24576
    v_mfma_f32_16x16x32_bf16 v[160:163], v[28:31], v[48:51], 0
    ds_read_b64_tr_b16 v[82:83], v18 offset:25600
    v_mfma_f32_16x16x32_bf16 v[164:167], v[28:31], v[52:55], 0
    ds_read_b64_tr_b16 v[84:85], v19 offset:24576
    v_mfma_f32_16x16x32_bf16 v[132:135], v[24:27], v[52:55], 0
    ds_read_b64_tr_b16 v[86:87], v19 offset:25600
    v_mfma_f32_16x16x32_bf16 v[136:139], v[24:27], v[56:59], 0
    ds_read_b128 v[88:91], v21 offset:32768
    v_mfma_f32_16x16x32_bf16 v[168:171], v[28:31], v[56:59], 0
    ds_read_b128 v[92:95], v21 offset:34816
    v_mfma_f32_16x16x32_bf16 v[172:175], v[28:31], v[60:63], 0
    ds_read_b128 v[96:99], v21 offset:36864
    v_mfma_f32_16x16x32_bf16 v[140:143], v[24:27], v[60:63], 0
    ds_read_b128 v[100:103], v21 offset:38912
    v_mfma_f32_16x16x32_bf16 v[144:147], v[24:27], v[64:67], 0
    ds_read_b128 v[104:107], v21 offset:40960
    v_mfma_f32_16x16x32_bf16 v[176:179], v[28:31], v[64:67], 0
    ds_read_b128 v[108:111], v21 offset:43008
    v_mfma_f32_16x16x32_bf16 v[180:183], v[28:31], v[68:71], 0
    ds_read_b128 v[112:115], v21 offset:45056
    v_mfma_f32_16x16x32_bf16 v[148:151], v[24:27], v[68:71], 0
    ds_read_b128 v[116:119], v21 offset:47104
    v_mfma_f32_16x16x32_bf16 v[212:215], v[32:35], v[68:71], 0
    s_mov_b32 s57, 1
    s_cmp_eq_u32 s57, 1
    v_mfma_f32_16x16x32_bf16 v[244:247], v[36:39], v[68:71], 0
    v_mfma_f32_16x16x32_bf16 v[240:243], v[36:39], v[64:67], 0
    v_mfma_f32_16x16x32_bf16 v[208:211], v[32:35], v[64:67], 0
    v_mfma_f32_16x16x32_bf16 v[204:207], v[32:35], v[60:63], 0
    v_mfma_f32_16x16x32_bf16 v[236:239], v[36:39], v[60:63], 0
    v_mfma_f32_16x16x32_bf16 v[232:235], v[36:39], v[56:59], 0
    v_mfma_f32_16x16x32_bf16 v[200:203], v[32:35], v[56:59], 0
    v_mfma_f32_16x16x32_bf16 v[196:199], v[32:35], v[52:55], 0
    v_mfma_f32_16x16x32_bf16 v[228:231], v[36:39], v[52:55], 0
    v_mfma_f32_16x16x32_bf16 v[224:227], v[36:39], v[48:51], 0
    v_mfma_f32_16x16x32_bf16 v[192:195], v[32:35], v[48:51], 0
    v_mfma_f32_16x16x32_bf16 v[188:191], v[32:35], v[44:47], 0
    v_mfma_f32_16x16x32_bf16 v[220:223], v[36:39], v[44:47], 0
    v_mfma_f32_16x16x32_bf16 v[216:219], v[36:39], v[40:43], 0
    v_mfma_f32_16x16x32_bf16 v[184:187], v[32:35], v[40:43], 0
    s_branch L_quip_kernela1_m1
L_quip_kernela1_fl:
    s_mov_b32 s58, 2
    s_waitcnt vmcnt(0)
    v_readfirstlane_b32 s65, v11
    s_cmp_lg_u32 s65, 0
    s_cbranch_scc1 L_quip_kernela1_fl2
    v_mov_b32 v10, 0
    s_mov_b32 s71, 0
L_noncea1:
    global_load_dword v11, v10, s[18:19] sc1
    s_add_u32 s71, s71, 1
    s_waitcnt vmcnt(0)
    v_readfirstlane_b32 s65, v11
    s_cmp_gt_u32 s71, 65536
    s_cbranch_scc1 L_noncea1_ok
    s_cmp_eq_u32 s65, 0
    s_cbranch_scc1 L_noncea1
L_noncea1_ok:
L_quip_kernela1_fl2:
    v_mov_b32 v10, 0
    v_mov_b32 v11, s65
    s_mov_b64 exec, 1
    buffer_store_dword v11, v10, s[32:35], s70 offen sc1
    s_mov_b64 exec, -1
    s_add_u32 s70, s70, 64
    s_branch L_quip_kernela1_flb
L_quip_kernela1_fin:
    s_waitcnt vmcnt(0)
    v_mov_b32 v10, 0
    v_mov_b32 v11, s65
    s_mov_b64 exec, 1
    buffer_store_dword v11, v10, s[32:35], s70 offen sc1
    s_mov_b64 exec, -1
    s_add_u32 s70, s70, 64
    s_waitcnt lgkmcnt(0)
L_quip_kernel_end:
    s_endpgm
.section .rodata,"a"
.p2align 6
.amdhsa_kernel standalone__weight_only_int_quip__prompt_kernel
  .amdhsa_next_free_vgpr 248
  .amdhsa_next_free_sgpr 102
  .amdhsa_accum_offset 248
  .amdhsa_group_segment_fixed_size 0
  .amdhsa_kernarg_size 72
  .amdhsa_user_sgpr_count 2
  .amdhsa_user_sgpr_kernarg_segment_ptr 1
  .amdhsa_system_sgpr_workgroup_id_x 1
  .amdhsa_float_denorm_mode_32 3
  .amdhsa_float_denorm_mode_16_64 3
.end_amdhsa_kernel
```
